```python
import torch

def _softmax(x, axis=-1):
    return torch.softmax(x, dim=axis)
def _gelu(x):
    return torch.nn.functional.gelu(x, approximate="tanh")
def _silu(x):
    return torch.nn.functional.silu(x)
def _sigmoid(x):
    return torch.sigmoid(x)
def _layernorm(x, axis=-1, eps=1e-5):
    m = x.mean(dim=axis, keepdim=True)
    v = x.var(dim=axis, keepdim=True, unbiased=False)
    return (x - m) / torch.sqrt(v + eps)
def _scatter_add(tgt, idx, src, axis=0):
    return tgt.clone().index_add_(axis, idx, src)
def _segment_sum(src, seg, n):
    out = torch.zeros((n,) + src.shape[1:], dtype=src.dtype)
    return out.index_add_(0, seg, src)
def _pad(x, pw):
    flat = tuple(v for pair in reversed(pw) for v in pair)
    return torch.nn.functional.pad(x, flat)

kernel_name = 'standalone__deep_cross_wide_deep__recsys'

def setup_inputs():

    _w = (lambda a: (lambda t: t.to(torch.bfloat16) if t.is_floating_point() else t)(torch.as_tensor(a)))
    B, F, D = 16384, 100, 64
    V, Nd = min(1000, 100000), 13
    Din = F * D
    H = 4 * D
    return {
        "idx": _w((lambda lo, hi, *s: torch.randint(lo, hi, s))(0, V, B, F).to(torch.int64)),
        "table": _w((lambda *s: torch.randn(*s, dtype=torch.bfloat16) * 1.6)(V, D) * 0.05),
        "x_wide": _w((lambda *s: torch.randn(*s, dtype=torch.bfloat16) * 0.8)(B, Nd)),
        "w_wide": _w((lambda *s: torch.randn(*s, dtype=torch.bfloat16) * 0.8)(Nd) * 0.05),
        "b_wide": _w((lambda *s: torch.randn(*s, dtype=torch.bfloat16) * 0.8)(1) * 0.01),
        "W1": _w((lambda *s: torch.randn(*s, dtype=torch.bfloat16) * 1.6)(Din, H) * (2.0 / Din) ** 0.5),
        "b1": _w((lambda *s: torch.randn(*s, dtype=torch.bfloat16) * 1.6)(H) * 0.01),
        "W2": _w((lambda *s: torch.randn(*s, dtype=torch.bfloat16) * 1.6)(H) * (1.0 / H) ** 0.5),
        "b2": _w((lambda *s: torch.randn(*s, dtype=torch.bfloat16) * 1.6)(1) * 0.01),
    }

def reference(idx, table, x_wide, w_wide, b_wide, W1, b1, W2, b2):
    emb = table[idx]
    deep_in = emb.reshape(emb.shape[0], -1)
    h = deep_in @ W1 + b1
    h = h * (lambda x, dt: x.to(dt))(h > 0, h.dtype)
    deep_logit = h @ W2 + b2
    wide_logit = x_wide @ w_wide + b_wide
    return _sigmoid(wide_logit + deep_logit)
```

```asm
; @launch grid=(256,1,1) block=(512,1,1) lds=163840
.amdgcn_target "amdgcn-amd-amdhsa--gfx950"
.text
.globl standalone__deep_cross_wide_deep__recsys_kernel
.p2align 8
.type standalone__deep_cross_wide_deep__recsys_kernel,@function
standalone__deep_cross_wide_deep__recsys_kernel:
s_cmp_ge_u32 s2, 256
s_cbranch_scc1 done
s_load_dwordx16 s[32:47], s[0:1], 0
s_load_dwordx8 s[48:55], s[0:1], 64
v_lshrrev_b32 v1, 6, v0
v_and_b32 v8, 63, v0
v_readfirstlane_b32 s3, v1
s_bfe_u32 s26, s2, 0x20002
s_and_b32 s27, s2, 3
s_lshl_b32 s27, s27, 4
s_lshr_b32 s30, s2, 4
s_add_u32 s27, s27, s30
s_lshl_b32 s28, s26, 6
s_add_u32 s28, s28, s27
s_lshl_b32 s23, s3, 12
v_mov_b32 v18, 0
v_mov_b32 v14, 0
v_mov_b32 v15, 0
v_mov_b32 v19, 0
s_mul_i32 s71, s28, 25600
s_mov_b32 s10, 0x640000
s_mov_b32 s11, 0x20000
s_mov_b32 s18, 0x320000
s_mov_b32 s19, 0x20000
s_cmp_lt_u32 s3, 4
s_cbranch_scc1 a_old
s_cmp_eq_u32 s3, 7
s_cbranch_scc1 a_w7
s_cmp_eq_u32 s3, 6
s_cbranch_scc1 a_pc
s_setprio 3
s_sub_u32 s25, s3, 4
v_lshrrev_b32 v10, 2, v8
v_mul_u32_u24 v10, 400, v10
v_and_b32 v11, 3, v8
v_lshl_add_u32 v10, v11, 4, v10
s_lshl_b32 s30, s25, 6
s_add_u32 s30, s30, s71
s_lshl_b32 s31, s25, 12
s_add_u32 s31, s31, 131072
s_mov_b32 m0, s31
v_lshl_add_u32 v17, v8, 6, s31
s_waitcnt lgkmcnt(0)
s_mov_b32 s8, s32
s_mov_b32 s9, s33
buffer_load_dwordx4 v10, s[8:11], s30 offen lds
s_add_u32 m0, m0, 1024
s_add_u32 s30, s30, 6400
buffer_load_dwordx4 v10, s[8:11], s30 offen lds
s_add_u32 m0, m0, 1024
s_add_u32 s30, s30, 6400
buffer_load_dwordx4 v10, s[8:11], s30 offen lds
s_add_u32 m0, m0, 1024
s_add_u32 s30, s30, 6400
buffer_load_dwordx4 v10, s[8:11], s30 offen lds
s_barrier
s_branch b_x
a_pc:
s_setprio 3
v_lshrrev_b32 v10, 2, v8
v_and_b32 v11, 1, v8
v_and_b32 v12, 2, v8
v_lshlrev_b32 v13, 3, v10
v_lshl_or_b32 v13, v11, 15, v13
v_lshl_or_b32 v13, v12, 11, v13
s_lshr_b32 s30, s27, 2
s_lshl_b32 s30, s30, 16
s_and_b32 s31, s27, 3
s_lshl_b32 s31, s31, 13
s_add_u32 s30, s30, s31
s_lshl_b32 s31, s26, 7
s_add_u32 s30, s30, s31
s_add_u32 s30, s30, 0x100000
s_waitcnt lgkmcnt(0)
s_mov_b32 s16, s42
s_mov_b32 s17, s43
buffer_load_dwordx2 v[128:129], v13, s[16:19], s30 offen offset:0
buffer_load_dwordx2 v[130:131], v13, s[16:19], s30 offen offset:512
buffer_load_dwordx2 v[132:133], v13, s[16:19], s30 offen offset:1024
buffer_load_dwordx2 v[134:135], v13, s[16:19], s30 offen offset:1536
buffer_load_dwordx2 v[136:137], v13, s[16:19], s30 offen offset:2048
buffer_load_dwordx2 v[138:139], v13, s[16:19], s30 offen offset:2560
buffer_load_dwordx2 v[140:141], v13, s[16:19], s30 offen offset:3072
buffer_load_dwordx2 v[142:143], v13, s[16:19], s30 offen offset:3584
s_barrier
s_branch b_pc
a_old:
v_mov_b32 v10, 139264
ds_write_b64 v10, v[18:19]
v_and_b32 v16, 31, v8
v_lshlrev_b32 v16, 9, v16
s_lshr_b32 s31, s2, 3
s_lshl_b32 s31, s31, 14
s_lshl_b32 s30, s27, 3
s_add_u32 s31, s31, s30
s_and_b32 s30, s26, 1
s_lshl_b32 s30, s30, 19
s_add_u32 s31, s31, s30
s_waitcnt lgkmcnt(0)
s_barrier
s_mov_b32 s16, s42
s_mov_b32 s17, s43
s_cmp_lg_u32 s3, 3
s_cbranch_scc1 1f
buffer_load_dword v192, v16, s[16:19], s31 offen
1:
s_branch c_all
a_w7:
s_getpc_b64 s[70:71]
cpf_base:
s_lshr_b32 s31, s2, 3
s_mul_i32 s31, s31, 1152
v_min_u32 v2, 8, v8
v_lshl_add_u32 v2, v2, 7, s31
v_min_u32 v2, done-cpf_base, v2
v_mov_b32 v3, s71
v_add_co_u32 v2, vcc, s70, v2
s_nop 1
v_addc_co_u32 v3, vcc, 0, v3, vcc
global_load_dword v192, v[2:3], off
s_setprio 2
s_barrier
v_bfe_u32 v16, v8, 1, 4
v_lshlrev_b32 v18, 15, v16
v_lshrrev_b32 v16, 5, v8
v_lshl_or_b32 v18, v16, 12, v18
v_and_b32 v16, 1, v8
v_lshl_or_b32 v18, v16, 2, v18
v_and_b32 v16, 31, v8
v_lshlrev_b32 v16, 7, v16
s_lshr_b32 s31, s2, 3
s_lshl_b32 s31, s31, 12
s_lshl_b32 s71, s27, 3
s_and_b32 s30, s26, 1
s_lshl_b32 s30, s30, 19
s_add_u32 s71, s71, s30
s_waitcnt lgkmcnt(0)
s_mov_b32 s16, s42
s_mov_b32 s17, s43
s_mov_b32 s12, s34
s_mov_b32 s13, s35
s_mov_b32 s14, 0x1f400
s_mov_b32 s15, 0x20000
buffer_load_dword v192, v16, s[12:15], s31 offen
buffer_load_dword v128, v18, s[16:19], s71 offen offset:0
buffer_load_dword v129, v18, s[16:19], s71 offen offset:512
buffer_load_dword v130, v18, s[16:19], s71 offen offset:1024
buffer_load_dword v131, v18, s[16:19], s71 offen offset:1536
buffer_load_dword v132, v18, s[16:19], s71 offen offset:2048
buffer_load_dword v133, v18, s[16:19], s71 offen offset:2560
buffer_load_dword v134, v18, s[16:19], s71 offen offset:3072
buffer_load_dword v135, v18, s[16:19], s71 offen offset:3584
s_add_u32 s71, s71, 8192
buffer_load_dword v136, v18, s[16:19], s71 offen offset:0
buffer_load_dword v137, v18, s[16:19], s71 offen offset:512
buffer_load_dword v138, v18, s[16:19], s71 offen offset:1024
buffer_load_dword v139, v18, s[16:19], s71 offen offset:1536
s_branch c_all
b_x:
s_load_dword s29, s[54:55], 39552
s_mov_b32 s4, s54
s_mov_b32 s5, s55
s_mov_b32 s6, 0x2000000
s_mov_b32 s7, 0x20000
s_mov_b32 s12, s34
s_mov_b32 s13, s35
s_mov_b32 s14, 0x1f400
s_mov_b32 s15, 0x20000
v_and_b32 v16, 28, v8
v_lshlrev_b32 v0, 8, v16
v_and_b32 v16, 1, v8
v_lshl_or_b32 v0, v16, 6, v0
v_and_b32 v16, 32, v8
v_or_b32 v0, v0, v16
v_and_b32 v16, 2, v8
v_lshl_or_b32 v0, v16, 3, v0
v_and_b32 v16, 15, v8
v_lshl_add_u32 v128, v16, 2, v17
v_xor_b32 v17, 1, v16
v_lshl_or_b32 v176, v17, 16, v16
v_xor_b32 v129, 4, v128
v_xor_b32 v130, 8, v128
v_xor_b32 v131, 12, v128
v_xor_b32 v132, 16, v128
v_xor_b32 v133, 20, v128
v_xor_b32 v134, 24, v128
v_xor_b32 v135, 28, v128
v_xor_b32 v136, 32, v128
v_xor_b32 v137, 36, v128
v_xor_b32 v138, 40, v128
v_xor_b32 v139, 44, v128
v_xor_b32 v140, 48, v128
v_xor_b32 v141, 52, v128
v_xor_b32 v142, 56, v128
v_xor_b32 v143, 60, v128
v_xor_b32 v177, 0x20002, v176
v_xor_b32 v178, 0x40004, v176
v_xor_b32 v179, 0x60006, v176
v_xor_b32 v180, 0x80008, v176
v_xor_b32 v181, 0xa000a, v176
v_xor_b32 v182, 0xc000c, v176
v_xor_b32 v183, 0xe000e, v176
s_lshr_b32 s70, s28, 3
s_mul_i32 s70, s70, 102400
s_add_u32 s70, s70, 0x10000
s_bfe_u32 s30, s28, 0x10002
s_lshl_b32 s30, s30, 13
s_add_u32 s70, s70, s30
s_and_b32 s30, s28, 3
s_lshl_b32 s30, s30, 8
s_add_u32 s70, s70, s30
s_lshl_b32 s30, s25, 14
s_add_u32 s70, s70, s30
s_add_u32 s71, s70, 16384
s_waitcnt vmcnt(0)
ds_read_b32 v144, v128 offset:0
ds_read_b32 v145, v129 offset:0
ds_read_b32 v146, v130 offset:0
ds_read_b32 v147, v131 offset:0
ds_read_b32 v148, v132 offset:0
ds_read_b32 v149, v133 offset:0
ds_read_b32 v150, v134 offset:0
ds_read_b32 v151, v135 offset:0
ds_read_b32 v152, v136 offset:0
ds_read_b32 v153, v137 offset:0
ds_read_b32 v154, v138 offset:0
ds_read_b32 v155, v139 offset:0
ds_read_b32 v156, v140 offset:0
ds_read_b32 v157, v141 offset:0
ds_read_b32 v158, v142 offset:0
ds_read_b32 v159, v143 offset:0
s_waitcnt lgkmcnt(14)
v_lshl_add_u32 v144, v145, 16, v144
v_lshl_add_u32 v160, v144, 4, v176
s_waitcnt lgkmcnt(12)
v_lshl_add_u32 v146, v147, 16, v146
v_lshl_add_u32 v161, v146, 4, v177
s_waitcnt lgkmcnt(10)
v_lshl_add_u32 v148, v149, 16, v148
v_lshl_add_u32 v162, v148, 4, v178
s_waitcnt lgkmcnt(8)
v_lshl_add_u32 v150, v151, 16, v150
v_lshl_add_u32 v163, v150, 4, v179
buffer_store_dwordx4 v[160:163], v0, s[4:7], s70 offen offset:0 sc1
s_waitcnt lgkmcnt(6)
v_lshl_add_u32 v152, v153, 16, v152
v_lshl_add_u32 v164, v152, 4, v180
s_waitcnt lgkmcnt(4)
v_lshl_add_u32 v154, v155, 16, v154
v_lshl_add_u32 v165, v154, 4, v181
s_waitcnt lgkmcnt(2)
v_lshl_add_u32 v156, v157, 16, v156
v_lshl_add_u32 v166, v156, 4, v182
s_waitcnt lgkmcnt(0)
v_lshl_add_u32 v158, v159, 16, v158
v_lshl_add_u32 v167, v158, 4, v183
buffer_store_dwordx4 v[164:167], v0, s[4:7], s70 offen offset:128 sc1
s_barrier
s_branch c_all2
b_pc:
s_load_dword s29, s[54:55], 39552
s_mov_b32 s4, s54
s_mov_b32 s5, s55
s_mov_b32 s6, 0x2000000
s_mov_b32 s7, 0x20000
s_mov_b32 s12, s34
s_mov_b32 s13, s35
s_mov_b32 s14, 0x1f400
s_mov_b32 s15, 0x20000
v_and_b32 v16, 28, v8
v_lshlrev_b32 v0, 8, v16
v_and_b32 v16, 1, v8
v_lshl_or_b32 v0, v16, 6, v0
v_and_b32 v16, 32, v8
v_or_b32 v0, v0, v16
v_and_b32 v16, 2, v8
v_lshl_or_b32 v0, v16, 3, v0
v_mul_u32_u24 v18, 34816, v10
v_and_b32 v10, 3, v8
v_lshl_add_u32 v18, v10, 4, v18
s_mul_i32 s70, s26, 557056
s_lshr_b32 s30, s27, 2
s_lshl_b32 s30, s30, 10
s_add_u32 s70, s70, s30
s_and_b32 s30, s27, 3
s_lshl_b32 s30, s30, 7
s_add_u32 s70, s70, s30
s_add_u32 s70, s70, 0x340000
s_waitcnt vmcnt(0)
s_mov_b32 s30, 0x05040100
s_mov_b32 s31, 0x07060302
v_perm_b32 v160, v130, v128, s30
v_perm_b32 v161, v134, v132, s30
v_perm_b32 v162, v138, v136, s30
v_perm_b32 v163, v142, v140, s30
buffer_store_dwordx4 v[160:163], v18, s[4:7], s70 offen offset:0 sc1
v_perm_b32 v164, v130, v128, s31
v_perm_b32 v165, v134, v132, s31
v_perm_b32 v166, v138, v136, s31
v_perm_b32 v167, v142, v140, s31
buffer_store_dwordx4 v[164:167], v18, s[4:7], s70 offen offset:512 sc1
v_perm_b32 v168, v131, v129, s30
v_perm_b32 v169, v135, v133, s30
v_perm_b32 v170, v139, v137, s30
v_perm_b32 v171, v143, v141, s30
buffer_store_dwordx4 v[168:171], v18, s[4:7], s70 offen offset:64 sc1
v_perm_b32 v172, v131, v129, s31
v_perm_b32 v173, v135, v133, s31
v_perm_b32 v174, v139, v137, s31
v_perm_b32 v175, v143, v141, s31
buffer_store_dwordx4 v[172:175], v18, s[4:7], s70 offen offset:576 sc1
s_barrier
s_branch c_all2
c_all:
s_load_dword s29, s[54:55], 39552
s_mov_b32 s4, s54
s_mov_b32 s5, s55
s_mov_b32 s6, 0x2000000
s_mov_b32 s7, 0x20000
s_mov_b32 s12, s34
s_mov_b32 s13, s35
s_mov_b32 s14, 0x1f400
s_mov_b32 s15, 0x20000
v_and_b32 v16, 28, v8
v_lshlrev_b32 v0, 8, v16
v_and_b32 v16, 1, v8
v_lshl_or_b32 v0, v16, 6, v0
v_and_b32 v16, 32, v8
v_or_b32 v0, v0, v16
v_and_b32 v16, 2, v8
v_lshl_or_b32 v0, v16, 3, v0
c_all2:
v_lshlrev_b32 v9, 4, v8
v_lshrrev_b32 v16, 4, v8
v_and_b32 v17, 7, v8
v_xor_b32 v16, v16, v17
v_lshlrev_b32 v16, 4, v16
v_lshrrev_b32 v17, 3, v8
v_lshl_or_b32 v14, v17, 7, v16
v_xor_b32 v15, 64, v14
v_bfe_u32 v19, v8, 2, 2
v_bfe_u32 v20, v8, 4, 1
v_lshlrev_b32 v20, 1, v20
v_mov_b32 v21, 0x3f80
v_cmp_eq_u32 vcc, v19, v20
v_add_u32 v20, 1, v20
s_nop 0
v_cndmask_b32 v4, 0, v21, vcc
v_cndmask_b32 v5, 0, v21, vcc
v_cmp_eq_u32 vcc, v19, v20
v_and_b32 v19, 3, v8
s_nop 0
v_cndmask_b32 v6, 0, v21, vcc
v_cndmask_b32 v7, 0, v21, vcc
v_mul_u32_u24 v1, 0x5555, v19
s_and_b32 s31, s26, 1
s_lshl_b32 s31, s31, 13
s_mul_i32 s22, s27, 34816
s_add_u32 s22, s22, s31
s_add_u32 s22, s22, 0x340000
s_lshl_b32 s31, s31, 1
s_add_u32 s31, s31, 0x10000
s_lshl_b32 s30, s26, 3
s_add_u32 s30, s30, s3
s_mul_i32 s21, s30, 102400
s_add_u32 s21, s21, s31
s_xor_b32 s30, s30, 8
s_mul_i32 s20, s30, 102400
s_add_u32 s20, s20, s31
s_add_u32 s24, s23, 36736
s_lshl_b32 s31, s3, 3
v_and_b32 v13, 7, v8
v_add_u32 v10, s31, v13
s_and_b32 s31, s3, 3
s_and_b32 s30, s26, 1
s_lshl_b32 s30, s30, 5
s_add_u32 s31, s31, s30
v_lshl_add_u32 v11, v13, 2, s31
v_lshrrev_b32 v13, 3, v8
v_cmp_eq_u32 vcc, 1, v13
s_nop 1
v_cndmask_b32 v10, v10, v11, vcc
s_lshr_b32 s30, s27, 4
v_mov_b32 v11, s30
v_mov_b32 v16, s26
v_cmp_eq_u32 vcc, 0, v13
s_nop 1
v_cndmask_b32 v11, v11, v16, vcc
v_xor_b32 v16, 1, v16
v_cmp_eq_u32 vcc, 2, v13
s_nop 1
v_cndmask_b32 v11, v11, v16, vcc
v_lshl_add_u32 v10, v11, 6, v10
v_lshlrev_b32 v19, 7, v10
v_and_b32 v10, 24, v8
v_and_b32 v11, 3, v8
v_lshl_add_u32 v10, v11, 1, v10
v_bfe_u32 v12, v8, 2, 1
v_add_u32 v10, v10, v12
v_lshlrev_b32 v10, 7, v10
v_bfe_u32 v12, v8, 3, 1
v_lshl_or_b32 v11, v12, 2, v11
v_lshrrev_b32 v12, 5, v8
v_xor_b32 v11, v11, v12
v_lshl_or_b32 v10, v11, 4, v10
v_add_u32 v20, s23, v10
v_add_u32 v12, 155648, v9
v_xor_b32 v21, 32, v20
v_xor_b32 v22, 64, v20
v_xor_b32 v23, 96, v20
v_add_u32 v16, 131072, v9
s_lshl_b32 s31, s3, 10
v_add_u32 v17, s31, v16
s_cmp_eq_u32 s3, 7
s_cbranch_scc1 d_w7
s_cmp_lt_u32 s3, 4
s_cbranch_scc1 d_old
s_barrier
v_mov_b32 v10, 139264
v_mov_b32 v11, 1
s_mov_b64 exec, 1
s_waitcnt vmcnt(0)
ds_add_rtn_u32 v13, v10, v11
s_lshl_b32 s30, s28, 7
s_add_u32 s30, s30, 0x1000
v_mov_b32 v10, 0
s_waitcnt lgkmcnt(0)
v_readfirstlane_b32 s31, v13
v_not_b32 v11, s29
s_cmp_lg_u32 s31, 2
s_cbranch_scc1 b_nosig
buffer_store_dword v11, v10, s[4:7], s30 offen sc1
b_nosig:
s_mov_b64 exec, -1
s_setprio 0
s_branch e_join
d_w7:
s_mov_b32 s16, s42
s_mov_b32 s17, s43
s_barrier
buffer_load_dword v140, v18, s[16:19], s71 offen offset:2048
buffer_load_dword v141, v18, s[16:19], s71 offen offset:2560
buffer_load_dword v142, v18, s[16:19], s71 offen offset:3072
buffer_load_dword v143, v18, s[16:19], s71 offen offset:3584
s_add_u32 s71, s71, 8192
buffer_load_dword v144, v18, s[16:19], s71 offen offset:0
buffer_load_dword v145, v18, s[16:19], s71 offen offset:512
buffer_load_dword v146, v18, s[16:19], s71 offen offset:1024
buffer_load_dword v147, v18, s[16:19], s71 offen offset:1536
buffer_load_dword v148, v18, s[16:19], s71 offen offset:2048
buffer_load_dword v149, v18, s[16:19], s71 offen offset:2560
buffer_load_dword v150, v18, s[16:19], s71 offen offset:3072
buffer_load_dword v151, v18, s[16:19], s71 offen offset:3584
s_add_u32 s71, s71, 8192
buffer_load_dword v152, v18, s[16:19], s71 offen offset:0
buffer_load_dword v153, v18, s[16:19], s71 offen offset:512
buffer_load_dword v154, v18, s[16:19], s71 offen offset:1024
buffer_load_dword v155, v18, s[16:19], s71 offen offset:1536
buffer_load_dword v156, v18, s[16:19], s71 offen offset:2048
buffer_load_dword v157, v18, s[16:19], s71 offen offset:2560
buffer_load_dword v158, v18, s[16:19], s71 offen offset:3072
buffer_load_dword v159, v18, s[16:19], s71 offen offset:3584
s_barrier
s_add_u32 s30, s23, 0
s_mov_b32 m0, s30
s_nop 0
buffer_load_dwordx4 v14, s[12:15], s30 offen offset:0 lds
buffer_load_dwordx4 v15, s[12:15], s30 offen offset:1024 lds
buffer_load_dwordx4 v14, s[12:15], s30 offen offset:2048 lds
buffer_load_dwordx4 v15, s[12:15], s30 offen offset:3072 lds
s_add_u32 s30, s23, 32768
s_mov_b32 m0, s30
s_nop 0
buffer_load_dwordx4 v14, s[12:15], s30 offen offset:0 lds
buffer_load_dwordx4 v15, s[12:15], s30 offen offset:1024 lds
buffer_load_dwordx4 v14, s[12:15], s30 offen offset:2048 lds
buffer_load_dwordx4 v15, s[12:15], s30 offen offset:3072 lds
s_mov_b32 s30, 0x05040100
s_mov_b32 s31, 0x07060302
s_waitcnt vmcnt(32)
v_perm_b32 v160, v129, v128, s30
v_perm_b32 v164, v129, v128, s31
v_perm_b32 v161, v131, v130, s30
v_perm_b32 v165, v131, v130, s31
v_perm_b32 v162, v133, v132, s30
v_perm_b32 v166, v133, v132, s31
v_perm_b32 v163, v135, v134, s30
v_perm_b32 v167, v135, v134, s31
ds_write_b128 v12, v[160:163] offset:0
ds_write_b128 v12, v[164:167] offset:4096
s_waitcnt vmcnt(24)
v_perm_b32 v168, v137, v136, s30
v_perm_b32 v172, v137, v136, s31
v_perm_b32 v169, v139, v138, s30
v_perm_b32 v173, v139, v138, s31
v_perm_b32 v170, v141, v140, s30
v_perm_b32 v174, v141, v140, s31
v_perm_b32 v171, v143, v142, s30
v_perm_b32 v175, v143, v142, s31
ds_write_b128 v12, v[168:171] offset:1024
ds_write_b128 v12, v[172:175] offset:5120
s_waitcnt vmcnt(16)
v_perm_b32 v176, v145, v144, s30
v_perm_b32 v180, v145, v144, s31
v_perm_b32 v177, v147, v146, s30
v_perm_b32 v181, v147, v146, s31
v_perm_b32 v178, v149, v148, s30
v_perm_b32 v182, v149, v148, s31
v_perm_b32 v179, v151, v150, s30
v_perm_b32 v183, v151, v150, s31
ds_write_b128 v12, v[176:179] offset:2048
ds_write_b128 v12, v[180:183] offset:6144
s_waitcnt vmcnt(8)
v_perm_b32 v184, v153, v152, s30
v_perm_b32 v188, v153, v152, s31
v_perm_b32 v185, v155, v154, s30
v_perm_b32 v189, v155, v154, s31
v_perm_b32 v186, v157, v156, s30
v_perm_b32 v190, v157, v156, s31
v_perm_b32 v187, v159, v158, s30
v_perm_b32 v191, v159, v158, s31
ds_write_b128 v12, v[184:187] offset:3072
ds_write_b128 v12, v[188:191] offset:7168
s_branch b_all
d_old:
s_barrier
s_barrier
e_join:
s_add_u32 s30, s23, 0
s_mov_b32 m0, s30
s_nop 0
buffer_load_dwordx4 v14, s[12:15], s30 offen offset:0 lds
buffer_load_dwordx4 v15, s[12:15], s30 offen offset:1024 lds
buffer_load_dwordx4 v14, s[12:15], s30 offen offset:2048 lds
buffer_load_dwordx4 v15, s[12:15], s30 offen offset:3072 lds
s_add_u32 s30, s23, 32768
s_mov_b32 m0, s30
s_nop 0
buffer_load_dwordx4 v14, s[12:15], s30 offen offset:0 lds
buffer_load_dwordx4 v15, s[12:15], s30 offen offset:1024 lds
buffer_load_dwordx4 v14, s[12:15], s30 offen offset:2048 lds
buffer_load_dwordx4 v15, s[12:15], s30 offen offset:3072 lds
s_setprio 0
b_all:
s_setprio 0
s_waitcnt lgkmcnt(0)
s_barrier
ds_read_b128 v[224:227], v12 offset:0
ds_read_b128 v[228:231], v12 offset:1024
ds_read_b128 v[232:235], v12 offset:2048
ds_read_b128 v[236:239], v12 offset:3072
ds_read_b128 v[240:243], v12 offset:4096
ds_read_b128 v[244:247], v12 offset:5120
ds_read_b128 v[248:251], v12 offset:6144
ds_read_b128 v[252:255], v12 offset:7168
s_not_b32 s29, s29
s_add_u32 s30, s23, 65536
s_mov_b32 m0, s30
s_nop 0
buffer_load_dwordx4 v14, s[12:15], s30 offen offset:0 lds
buffer_load_dwordx4 v15, s[12:15], s30 offen offset:1024 lds
buffer_load_dwordx4 v14, s[12:15], s30 offen offset:2048 lds
buffer_load_dwordx4 v15, s[12:15], s30 offen offset:3072 lds
s_waitcnt vmcnt(8)
ds_read_b128 v[32:35], v20 offset:0
ds_read_b128 v[36:39], v21 offset:0
ds_read_b128 v[40:43], v22 offset:0
ds_read_b128 v[44:47], v23 offset:0
s_waitcnt lgkmcnt(0)
v_mfma_f32_32x32x16_bf16 v[96:111], v[32:35], v[224:227], 0
v_mfma_f32_32x32x16_bf16 v[112:127], v[32:35], v[240:243], 0
v_mfma_f32_32x32x16_bf16 v[96:111], v[36:39], v[228:231], v[96:111]
v_mfma_f32_32x32x16_bf16 v[112:127], v[36:39], v[244:247], v[112:127]
v_mfma_f32_32x32x16_bf16 v[96:111], v[40:43], v[232:235], v[96:111]
s_waitcnt vmcnt(4)
ds_read_b128 v[48:51], v20 offset:32768
ds_read_b128 v[52:55], v21 offset:32768
ds_read_b128 v[56:59], v22 offset:32768
ds_read_b128 v[60:63], v23 offset:32768
v_mfma_f32_32x32x16_bf16 v[112:127], v[40:43], v[248:251], v[112:127]
v_mfma_f32_32x32x16_bf16 v[96:111], v[44:47], v[236:239], v[96:111]
v_mfma_f32_32x32x16_bf16 v[112:127], v[44:47], v[252:255], v[112:127]
s_add_u32 s30, s23, 98304
s_mov_b32 m0, s30
s_nop 0
buffer_load_dwordx4 v14, s[12:15], s30 offen offset:0 lds
buffer_load_dwordx4 v15, s[12:15], s30 offen offset:1024 lds
buffer_load_dwordx4 v14, s[12:15], s30 offen offset:2048 lds
buffer_load_dwordx4 v15, s[12:15], s30 offen offset:3072 lds
s_mov_b32 s30, 0x1000
buffer_load_dword v10, v19, s[4:7], s30 offen sc1
s_waitcnt lgkmcnt(0)
v_mfma_f32_32x32x16_bf16 v[192:207], v[48:51], v[224:227], 0
s_nop 10
v_cvt_pk_bf16_f32 v160, v96, v112
v_cvt_pk_bf16_f32 v161, v97, v113
v_mfma_f32_32x32x16_bf16 v[208:223], v[48:51], v[240:243], 0
v_cvt_pk_bf16_f32 v162, v98, v114
v_cvt_pk_bf16_f32 v163, v99, v115
v_mfma_f32_32x32x16_bf16 v[192:207], v[52:55], v[228:231], v[192:207]
v_cvt_pk_bf16_f32 v164, v100, v116
v_cvt_pk_bf16_f32 v165, v101, v117
v_mfma_f32_32x32x16_bf16 v[208:223], v[52:55], v[244:247], v[208:223]
v_cvt_pk_bf16_f32 v166, v102, v118
v_cvt_pk_bf16_f32 v167, v103, v119
v_mfma_f32_32x32x16_bf16 v[192:207], v[56:59], v[232:235], v[192:207]
v_cvt_pk_bf16_f32 v168, v104, v120
v_cvt_pk_bf16_f32 v169, v105, v121
s_waitcnt vmcnt(5)
v_add_u32 v20, 0x10000, v20
v_add_u32 v21, 0x10000, v21
v_add_u32 v22, 0x10000, v22
v_add_u32 v23, 0x10000, v23
ds_read_b128 v[64:67], v20 offset:0
ds_read_b128 v[68:71], v21 offset:0
ds_read_b128 v[72:75], v22 offset:0
ds_read_b128 v[76:79], v23 offset:0
v_mfma_f32_32x32x16_bf16 v[208:223], v[56:59], v[248:251], v[208:223]
v_cvt_pk_bf16_f32 v170, v106, v122
v_cvt_pk_bf16_f32 v171, v107, v123
v_mfma_f32_32x32x16_bf16 v[192:207], v[60:63], v[236:239], v[192:207]
v_cvt_pk_bf16_f32 v172, v108, v124
v_cvt_pk_bf16_f32 v173, v109, v125
v_mfma_f32_32x32x16_bf16 v[208:223], v[60:63], v[252:255], v[208:223]
v_cvt_pk_bf16_f32 v174, v110, v126
v_cvt_pk_bf16_f32 v175, v111, v127
s_mov_b32 s25, 0
s_mov_b32 s30, 0x1000
s_waitcnt vmcnt(0)
poll1:
v_cmp_ne_u32 vcc, s29, v10
s_cbranch_vccz poll1_done
s_sleep 8
buffer_load_dword v10, v19, s[4:7], s30 offen sc1
s_add_u32 s25, s25, 1
s_waitcnt vmcnt(0)
s_cmp_lt_u32 s25, 0x40000
s_cbranch_scc1 poll1
poll1_done:
s_lshl_b32 s30, s3, 7
s_add_u32 s30, s30, s22
buffer_load_dwordx4 v[24:27], v0, s[4:7], s30 offen sc1
buffer_load_dwordx4 v[128:131], v0, s[4:7], s20 offen offset:0 sc1
buffer_load_dwordx4 v[132:135], v0, s[4:7], s20 offen offset:128 sc1
s_waitcnt lgkmcnt(0)
v_mfma_f32_32x32x16_bf16 v[96:111], v[64:67], v[224:227], 0
s_nop 10
v_cvt_pk_bf16_f32 v176, v192, v208
v_cvt_pk_bf16_f32 v177, v193, v209
s_mov_b32 m0, s23
s_nop 0
ds_write_addtid_b32 v160 offset:0
ds_write_addtid_b32 v161 offset:256
ds_write_addtid_b32 v162 offset:512
v_mfma_f32_32x32x16_bf16 v[112:127], v[64:67], v[240:243], 0
v_cvt_pk_bf16_f32 v178, v194, v210
v_cvt_pk_bf16_f32 v179, v195, v211
ds_write_addtid_b32 v163 offset:768
ds_write_addtid_b32 v164 offset:1024
ds_write_addtid_b32 v165 offset:1280
v_mfma_f32_32x32x16_bf16 v[96:111], v[68:71], v[228:231], v[96:111]
v_cvt_pk_bf16_f32 v180, v196, v212
v_cvt_pk_bf16_f32 v181, v197, v213
ds_write_addtid_b32 v166 offset:1536
ds_write_addtid_b32 v167 offset:1792
ds_write_addtid_b32 v168 offset:2048
v_mfma_f32_32x32x16_bf16 v[112:127], v[68:71], v[244:247], v[112:127]
v_cvt_pk_bf16_f32 v182, v198, v214
v_cvt_pk_bf16_f32 v183, v199, v215
ds_write_addtid_b32 v169 offset:2304
ds_write_addtid_b32 v170 offset:2560
ds_write_addtid_b32 v171 offset:2816
v_mfma_f32_32x32x16_bf16 v[96:111], v[72:75], v[232:235], v[96:111]
v_cvt_pk_bf16_f32 v184, v200, v216
v_cvt_pk_bf16_f32 v185, v201, v217
ds_write_addtid_b32 v172 offset:3072
ds_write_addtid_b32 v173 offset:3328
ds_write_addtid_b32 v174 offset:3584
s_waitcnt vmcnt(4)
ds_read_b128 v[80:83], v20 offset:32768
ds_read_b128 v[84:87], v21 offset:32768
ds_read_b128 v[88:91], v22 offset:32768
ds_read_b128 v[92:95], v23 offset:32768
v_mfma_f32_32x32x16_bf16 v[112:127], v[72:75], v[248:251], v[112:127]
v_cvt_pk_bf16_f32 v186, v202, v218
v_cvt_pk_bf16_f32 v187, v203, v219
ds_write_addtid_b32 v175 offset:3840
ds_write_addtid_b32 v176 offset:32768
ds_write_addtid_b32 v177 offset:33024
v_mfma_f32_32x32x16_bf16 v[96:111], v[76:79], v[236:239], v[96:111]
v_cvt_pk_bf16_f32 v188, v204, v220
v_cvt_pk_bf16_f32 v189, v205, v221
ds_write_addtid_b32 v178 offset:33280
ds_write_addtid_b32 v179 offset:33536
ds_write_addtid_b32 v180 offset:33792
v_mfma_f32_32x32x16_bf16 v[112:127], v[76:79], v[252:255], v[112:127]
v_cvt_pk_bf16_f32 v190, v206, v222
v_cvt_pk_bf16_f32 v191, v207, v223
ds_write_addtid_b32 v181 offset:34048
ds_write_addtid_b32 v182 offset:34304
ds_write_addtid_b32 v183 offset:34560
ds_write_addtid_b32 v184 offset:34816
ds_write_addtid_b32 v185 offset:35072
ds_write_addtid_b32 v186 offset:35328
buffer_load_dwordx4 v[136:139], v0, s[4:7], s20 offen offset:256 sc1
buffer_load_dwordx4 v[140:143], v0, s[4:7], s20 offen offset:384 sc1
buffer_load_dwordx4 v[144:147], v0, s[4:7], s20 offen offset:512 sc1
buffer_load_dwordx4 v[148:151], v0, s[4:7], s20 offen offset:640 sc1
buffer_load_dwordx4 v[152:155], v0, s[4:7], s20 offen offset:768 sc1
buffer_load_dwordx4 v[156:159], v0, s[4:7], s20 offen offset:896 sc1
s_waitcnt lgkmcnt(12)
v_mfma_f32_32x32x16_bf16 v[192:207], v[80:83], v[224:227], 0
s_nop 10
v_cvt_pk_bf16_f32 v96, v96, v112
v_mov_b32 v112, 0
v_cvt_pk_bf16_f32 v97, v97, v113
v_mov_b32 v113, 0
s_mov_b32 m0, s23
s_nop 0
ds_write_addtid_b32 v187 offset:35584
ds_write_addtid_b32 v188 offset:35840
ds_write_addtid_b32 v189 offset:36096
v_mfma_f32_32x32x16_bf16 v[208:223], v[80:83], v[240:243], 0
v_cvt_pk_bf16_f32 v98, v98, v114
v_mov_b32 v114, 0
v_cvt_pk_bf16_f32 v99, v99, v115
v_mov_b32 v115, 0
ds_write_addtid_b32 v190 offset:36352
ds_write_addtid_b32 v191 offset:36608
s_mov_b32 m0, s24
s_nop 0
ds_write_addtid_b32 v96 offset:28800
v_mfma_f32_32x32x16_bf16 v[192:207], v[84:87], v[228:231], v[192:207]
v_cvt_pk_bf16_f32 v100, v100, v116
v_mov_b32 v116, 0
v_cvt_pk_bf16_f32 v101, v101, v117
v_mov_b32 v117, 0
ds_write_addtid_b32 v97 offset:29056
ds_write_addtid_b32 v98 offset:29312
v_mov_b32 v96, 0
ds_write_addtid_b32 v99 offset:29568
v_mov_b32 v97, 0
v_mfma_f32_32x32x16_bf16 v[208:223], v[84:87], v[244:247], v[208:223]
v_cvt_pk_bf16_f32 v102, v102, v118
v_mov_b32 v118, 0
v_cvt_pk_bf16_f32 v103, v103, v119
v_mov_b32 v119, 0
ds_write_addtid_b32 v100 offset:29824
v_mov_b32 v98, 0
ds_write_addtid_b32 v101 offset:30080
v_mov_b32 v99, 0
v_mfma_f32_32x32x16_bf16 v[192:207], v[88:91], v[232:235], v[192:207]
v_cvt_pk_bf16_f32 v104, v104, v120
v_mov_b32 v120, 0
v_cvt_pk_bf16_f32 v105, v105, v121
v_mov_b32 v121, 0
ds_write_addtid_b32 v102 offset:30336
v_mov_b32 v100, 0
ds_write_addtid_b32 v103 offset:30592
v_mov_b32 v101, 0
v_mfma_f32_32x32x16_bf16 v[208:223], v[88:91], v[248:251], v[208:223]
v_cvt_pk_bf16_f32 v106, v106, v122
v_mov_b32 v122, 0
v_cvt_pk_bf16_f32 v107, v107, v123
v_mov_b32 v123, 0
ds_write_addtid_b32 v104 offset:30848
v_mov_b32 v102, 0
ds_write_addtid_b32 v105 offset:31104
v_mov_b32 v103, 0
v_mfma_f32_32x32x16_bf16 v[192:207], v[92:95], v[236:239], v[192:207]
v_cvt_pk_bf16_f32 v108, v108, v124
v_mov_b32 v124, 0
v_cvt_pk_bf16_f32 v109, v109, v125
v_mov_b32 v125, 0
ds_write_addtid_b32 v106 offset:31360
v_mov_b32 v104, 0
ds_write_addtid_b32 v107 offset:31616
v_mov_b32 v105, 0
v_mfma_f32_32x32x16_bf16 v[208:223], v[92:95], v[252:255], v[208:223]
v_cvt_pk_bf16_f32 v110, v110, v126
v_mov_b32 v126, 0
v_cvt_pk_bf16_f32 v111, v111, v127
v_mov_b32 v127, 0
ds_write_addtid_b32 v108 offset:31872
v_mov_b32 v106, 0
ds_write_addtid_b32 v109 offset:32128
v_mov_b32 v107, 0
ds_write_addtid_b32 v110 offset:32384
v_mov_b32 v108, 0
ds_write_addtid_b32 v111 offset:32640
v_mov_b32 v109, 0
s_waitcnt vmcnt(8)
ds_write_b128 v17, v[24:27]
s_waitcnt lgkmcnt(0)
s_barrier
ds_read_b128 v[224:227], v16 offset:0
ds_read_b128 v[228:231], v16 offset:1024
ds_read_b128 v[232:235], v16 offset:2048
ds_read_b128 v[236:239], v16 offset:3072
ds_read_b128 v[240:243], v16 offset:4096
ds_read_b128 v[244:247], v16 offset:5120
ds_read_b128 v[248:251], v16 offset:6144
ds_read_b128 v[252:255], v16 offset:7168
v_cvt_pk_bf16_f32 v192, v192, v208
v_cvt_pk_bf16_f32 v193, v193, v209
v_cvt_pk_bf16_f32 v194, v194, v210
v_cvt_pk_bf16_f32 v195, v195, v211
s_mov_b32 m0, s24
s_nop 0
ds_write_addtid_b32 v192 offset:61568
v_mov_b32 v110, 0
ds_write_addtid_b32 v193 offset:61824
v_mov_b32 v111, 0
v_cvt_pk_bf16_f32 v196, v196, v212
v_cvt_pk_bf16_f32 v197, v197, v213
ds_write_addtid_b32 v194 offset:62080
ds_write_addtid_b32 v195 offset:62336
v_cvt_pk_bf16_f32 v198, v198, v214
v_cvt_pk_bf16_f32 v199, v199, v215
ds_write_addtid_b32 v196 offset:62592
ds_write_addtid_b32 v197 offset:62848
v_cvt_pk_bf16_f32 v200, v200, v216
v_cvt_pk_bf16_f32 v201, v201, v217
ds_write_addtid_b32 v198 offset:63104
ds_write_addtid_b32 v199 offset:63360
v_cvt_pk_bf16_f32 v202, v202, v218
v_cvt_pk_bf16_f32 v203, v203, v219
ds_write_addtid_b32 v200 offset:63616
ds_write_addtid_b32 v201 offset:63872
v_cvt_pk_bf16_f32 v204, v204, v220
v_cvt_pk_bf16_f32 v205, v205, v221
ds_write_addtid_b32 v202 offset:64128
ds_write_addtid_b32 v203 offset:64384
v_cvt_pk_bf16_f32 v206, v206, v222
v_cvt_pk_bf16_f32 v207, v207, v223
ds_write_addtid_b32 v204 offset:64640
ds_write_addtid_b32 v205 offset:64896
ds_write_addtid_b32 v206 offset:65152
ds_write_addtid_b32 v207 offset:65408
s_cmp_lg_u32 s3, 7
s_cbranch_scc1 1f
v_mov_b32 v10, 128000
v_mov_b32 v11, 0
ds_write_b32 v10, v11
1:
s_waitcnt vmcnt(6)
v_lshlrev_b32_sdwa v2, 3, v128 dst_sel:DWORD dst_unused:UNUSED_PAD src0_sel:DWORD src1_sel:WORD_1
v_lshlrev_b32_sdwa v128, 3, v128 dst_sel:DWORD dst_unused:UNUSED_PAD src0_sel:DWORD src1_sel:WORD_0
v_lshlrev_b32_sdwa v3, 3, v129 dst_sel:DWORD dst_unused:UNUSED_PAD src0_sel:DWORD src1_sel:WORD_1
v_lshlrev_b32_sdwa v129, 3, v129 dst_sel:DWORD dst_unused:UNUSED_PAD src0_sel:DWORD src1_sel:WORD_0
s_mov_b32 s25, 3
s_waitcnt lgkmcnt(0)
s_barrier
ds_read_b64 v[8:9], v128
ds_read_b64 v[10:11], v2
ds_read_b64 v[12:13], v129
ds_read_b64 v[14:15], v3
v_mfma_f32_32x32x16_bf16 v[192:207], v[32:35], v[224:227], 0
s_add_u32 s30, s20, 8192
buffer_load_dwordx4 v[160:163], v0, s[4:7], s30 offen offset:0 sc1
v_lshlrev_b32_sdwa v2, 3, v130 dst_sel:DWORD dst_unused:UNUSED_PAD src0_sel:DWORD src1_sel:WORD_1
v_lshlrev_b32_sdwa v130, 3, v130 dst_sel:DWORD dst_unused:UNUSED_PAD src0_sel:DWORD src1_sel:WORD_0
v_lshlrev_b32_sdwa v3, 3, v131 dst_sel:DWORD dst_unused:UNUSED_PAD src0_sel:DWORD src1_sel:WORD_1
v_lshlrev_b32_sdwa v131, 3, v131 dst_sel:DWORD dst_unused:UNUSED_PAD src0_sel:DWORD src1_sel:WORD_0
ds_read_b64 v[16:17], v130
ds_read_b64 v[18:19], v2
ds_read_b64 v[20:21], v131
ds_read_b64 v[22:23], v3
v_mfma_f32_32x32x16_bf16 v[208:223], v[32:35], v[240:243], 0
v_mfma_f32_32x32x16_bf16 v[192:207], v[36:39], v[228:231], v[192:207]
s_add_u32 s30, s20, 8192
buffer_load_dwordx4 v[164:167], v0, s[4:7], s30 offen offset:128 sc1
v_lshlrev_b32_sdwa v2, 3, v132 dst_sel:DWORD dst_unused:UNUSED_PAD src0_sel:DWORD src1_sel:WORD_1
v_lshlrev_b32_sdwa v132, 3, v132 dst_sel:DWORD dst_unused:UNUSED_PAD src0_sel:DWORD src1_sel:WORD_0
v_lshlrev_b32_sdwa v3, 3, v133 dst_sel:DWORD dst_unused:UNUSED_PAD src0_sel:DWORD src1_sel:WORD_1
v_lshlrev_b32_sdwa v133, 3, v133 dst_sel:DWORD dst_unused:UNUSED_PAD src0_sel:DWORD src1_sel:WORD_0
ds_read_b64 v[24:25], v132
ds_read_b64 v[26:27], v2
ds_read_b64 v[28:29], v133
ds_read_b64 v[30:31], v3
v_mfma_f32_32x32x16_bf16 v[208:223], v[36:39], v[244:247], v[208:223]
s_add_u32 s30, s20, 8192
buffer_load_dwordx4 v[168:171], v0, s[4:7], s30 offen offset:256 sc1
v_lshlrev_b32_sdwa v2, 3, v134 dst_sel:DWORD dst_unused:UNUSED_PAD src0_sel:DWORD src1_sel:WORD_1
v_lshlrev_b32_sdwa v134, 3, v134 dst_sel:DWORD dst_unused:UNUSED_PAD src0_sel:DWORD src1_sel:WORD_0
v_lshlrev_b32_sdwa v3, 3, v135 dst_sel:DWORD dst_unused:UNUSED_PAD src0_sel:DWORD src1_sel:WORD_1
v_lshlrev_b32_sdwa v135, 3, v135 dst_sel:DWORD dst_unused:UNUSED_PAD src0_sel:DWORD src1_sel:WORD_0
s_waitcnt lgkmcnt(8)
v_smfmac_f32_16x16x64_bf16 v[96:99], v[4:7], v[8:15], v1
ds_read_b64 v[8:9], v134
ds_read_b64 v[10:11], v2
ds_read_b64 v[12:13], v135
ds_read_b64 v[14:15], v3
v_mfma_f32_32x32x16_bf16 v[192:207], v[40:43], v[232:235], v[192:207]
s_add_u32 s30, s20, 8192
buffer_load_dwordx4 v[172:175], v0, s[4:7], s30 offen offset:384 sc1
s_waitcnt vmcnt(8)
v_lshlrev_b32_sdwa v2, 3, v136 dst_sel:DWORD dst_unused:UNUSED_PAD src0_sel:DWORD src1_sel:WORD_1
v_lshlrev_b32_sdwa v136, 3, v136 dst_sel:DWORD dst_unused:UNUSED_PAD src0_sel:DWORD src1_sel:WORD_0
v_lshlrev_b32_sdwa v3, 3, v137 dst_sel:DWORD dst_unused:UNUSED_PAD src0_sel:DWORD src1_sel:WORD_1
v_lshlrev_b32_sdwa v137, 3, v137 dst_sel:DWORD dst_unused:UNUSED_PAD src0_sel:DWORD src1_sel:WORD_0
s_waitcnt lgkmcnt(8)
v_smfmac_f32_16x16x64_bf16 v[96:99], v[4:7], v[16:23], v1
ds_read_b64 v[16:17], v136
ds_read_b64 v[18:19], v2
ds_read_b64 v[20:21], v137
ds_read_b64 v[22:23], v3
v_mfma_f32_32x32x16_bf16 v[208:223], v[40:43], v[248:251], v[208:223]
v_lshlrev_b32_sdwa v2, 3, v138 dst_sel:DWORD dst_unused:UNUSED_PAD src0_sel:DWORD src1_sel:WORD_1
v_lshlrev_b32_sdwa v138, 3, v138 dst_sel:DWORD dst_unused:UNUSED_PAD src0_sel:DWORD src1_sel:WORD_0
v_lshlrev_b32_sdwa v3, 3, v139 dst_sel:DWORD dst_unused:UNUSED_PAD src0_sel:DWORD src1_sel:WORD_1
v_lshlrev_b32_sdwa v139, 3, v139 dst_sel:DWORD dst_unused:UNUSED_PAD src0_sel:DWORD src1_sel:WORD_0
s_waitcnt lgkmcnt(8)
v_smfmac_f32_16x16x64_bf16 v[96:99], v[4:7], v[24:31], v1
ds_read_b64 v[24:25], v138
ds_read_b64 v[26:27], v2
ds_read_b64 v[28:29], v139
ds_read_b64 v[30:31], v3
v_mfma_f32_32x32x16_bf16 v[192:207], v[44:47], v[236:239], v[192:207]
s_add_u32 s30, s20, 8192
buffer_load_dwordx4 v[176:179], v0, s[4:7], s30 offen offset:512 sc1
v_lshlrev_b32_sdwa v2, 3, v140 dst_sel:DWORD dst_unused:UNUSED_PAD src0_sel:DWORD src1_sel:WORD_1
v_lshlrev_b32_sdwa v140, 3, v140 dst_sel:DWORD dst_unused:UNUSED_PAD src0_sel:DWORD src1_sel:WORD_0
v_lshlrev_b32_sdwa v3, 3, v141 dst_sel:DWORD dst_unused:UNUSED_PAD src0_sel:DWORD src1_sel:WORD_1
v_lshlrev_b32_sdwa v141, 3, v141 dst_sel:DWORD dst_unused:UNUSED_PAD src0_sel:DWORD src1_sel:WORD_0
s_waitcnt lgkmcnt(8)
v_smfmac_f32_16x16x64_bf16 v[96:99], v[4:7], v[8:15], v1
ds_read_b64 v[8:9], v140
ds_read_b64 v[10:11], v2
ds_read_b64 v[12:13], v141
ds_read_b64 v[14:15], v3
v_mfma_f32_32x32x16_bf16 v[208:223], v[44:47], v[252:255], v[208:223]
s_add_u32 s30, s20, 8192
buffer_load_dwordx4 v[180:183], v0, s[4:7], s30 offen offset:640 sc1
v_lshlrev_b32_sdwa v2, 3, v142 dst_sel:DWORD dst_unused:UNUSED_PAD src0_sel:DWORD src1_sel:WORD_1
v_lshlrev_b32_sdwa v142, 3, v142 dst_sel:DWORD dst_unused:UNUSED_PAD src0_sel:DWORD src1_sel:WORD_0
v_lshlrev_b32_sdwa v3, 3, v143 dst_sel:DWORD dst_unused:UNUSED_PAD src0_sel:DWORD src1_sel:WORD_1
v_lshlrev_b32_sdwa v143, 3, v143 dst_sel:DWORD dst_unused:UNUSED_PAD src0_sel:DWORD src1_sel:WORD_0
s_waitcnt lgkmcnt(8)
v_smfmac_f32_16x16x64_bf16 v[100:103], v[4:7], v[16:23], v1
ds_read_b64 v[16:17], v142
ds_read_b64 v[18:19], v2
ds_read_b64 v[20:21], v143
ds_read_b64 v[22:23], v3
s_add_u32 s30, s20, 8192
buffer_load_dwordx4 v[184:187], v0, s[4:7], s30 offen offset:768 sc1
s_waitcnt vmcnt(9)
v_lshlrev_b32_sdwa v2, 3, v144 dst_sel:DWORD dst_unused:UNUSED_PAD src0_sel:DWORD src1_sel:WORD_1
v_lshlrev_b32_sdwa v144, 3, v144 dst_sel:DWORD dst_unused:UNUSED_PAD src0_sel:DWORD src1_sel:WORD_0
v_lshlrev_b32_sdwa v3, 3, v145 dst_sel:DWORD dst_unused:UNUSED_PAD src0_sel:DWORD src1_sel:WORD_1
v_lshlrev_b32_sdwa v145, 3, v145 dst_sel:DWORD dst_unused:UNUSED_PAD src0_sel:DWORD src1_sel:WORD_0
v_cvt_pk_bf16_f32 v128, v192, v208
v_cvt_pk_bf16_f32 v129, v193, v209
v_cvt_pk_bf16_f32 v130, v194, v210
v_cvt_pk_bf16_f32 v131, v195, v211
v_cvt_pk_bf16_f32 v132, v196, v212
v_cvt_pk_bf16_f32 v133, v197, v213
v_cvt_pk_bf16_f32 v134, v198, v214
v_cvt_pk_bf16_f32 v135, v199, v215
v_cvt_pk_bf16_f32 v136, v200, v216
v_cvt_pk_bf16_f32 v137, v201, v217
v_cvt_pk_bf16_f32 v138, v202, v218
v_cvt_pk_bf16_f32 v139, v203, v219
v_cvt_pk_bf16_f32 v140, v204, v220
v_cvt_pk_bf16_f32 v141, v205, v221
v_cvt_pk_bf16_f32 v142, v206, v222
v_cvt_pk_bf16_f32 v143, v207, v223
s_waitcnt lgkmcnt(8)
v_smfmac_f32_16x16x64_bf16 v[100:103], v[4:7], v[24:31], v1
ds_read_b64 v[24:25], v144
ds_read_b64 v[26:27], v2
ds_read_b64 v[28:29], v145
ds_read_b64 v[30:31], v3
v_mfma_f32_32x32x16_bf16 v[192:207], v[48:51], v[224:227], 0
s_add_u32 s30, s20, 8192
buffer_load_dwordx4 v[188:191], v0, s[4:7], s30 offen offset:896 sc1
v_lshlrev_b32_sdwa v2, 3, v146 dst_sel:DWORD dst_unused:UNUSED_PAD src0_sel:DWORD src1_sel:WORD_1
v_lshlrev_b32_sdwa v146, 3, v146 dst_sel:DWORD dst_unused:UNUSED_PAD src0_sel:DWORD src1_sel:WORD_0
v_lshlrev_b32_sdwa v3, 3, v147 dst_sel:DWORD dst_unused:UNUSED_PAD src0_sel:DWORD src1_sel:WORD_1
v_lshlrev_b32_sdwa v147, 3, v147 dst_sel:DWORD dst_unused:UNUSED_PAD src0_sel:DWORD src1_sel:WORD_0
s_waitcnt lgkmcnt(8)
v_smfmac_f32_16x16x64_bf16 v[100:103], v[4:7], v[8:15], v1
ds_read_b64 v[8:9], v146
ds_read_b64 v[10:11], v2
ds_read_b64 v[12:13], v147
ds_read_b64 v[14:15], v3
v_mfma_f32_32x32x16_bf16 v[208:223], v[48:51], v[240:243], 0
v_mfma_f32_32x32x16_bf16 v[192:207], v[52:55], v[228:231], v[192:207]
v_lshlrev_b32_sdwa v2, 3, v148 dst_sel:DWORD dst_unused:UNUSED_PAD src0_sel:DWORD src1_sel:WORD_1
v_lshlrev_b32_sdwa v148, 3, v148 dst_sel:DWORD dst_unused:UNUSED_PAD src0_sel:DWORD src1_sel:WORD_0
v_lshlrev_b32_sdwa v3, 3, v149 dst_sel:DWORD dst_unused:UNUSED_PAD src0_sel:DWORD src1_sel:WORD_1
v_lshlrev_b32_sdwa v149, 3, v149 dst_sel:DWORD dst_unused:UNUSED_PAD src0_sel:DWORD src1_sel:WORD_0
s_waitcnt lgkmcnt(8)
v_smfmac_f32_16x16x64_bf16 v[100:103], v[4:7], v[16:23], v1
ds_read_b64 v[16:17], v148
ds_read_b64 v[18:19], v2
ds_read_b64 v[20:21], v149
ds_read_b64 v[22:23], v3
v_mfma_f32_32x32x16_bf16 v[208:223], v[52:55], v[244:247], v[208:223]
v_lshlrev_b32_sdwa v2, 3, v150 dst_sel:DWORD dst_unused:UNUSED_PAD src0_sel:DWORD src1_sel:WORD_1
v_lshlrev_b32_sdwa v150, 3, v150 dst_sel:DWORD dst_unused:UNUSED_PAD src0_sel:DWORD src1_sel:WORD_0
v_lshlrev_b32_sdwa v3, 3, v151 dst_sel:DWORD dst_unused:UNUSED_PAD src0_sel:DWORD src1_sel:WORD_1
v_lshlrev_b32_sdwa v151, 3, v151 dst_sel:DWORD dst_unused:UNUSED_PAD src0_sel:DWORD src1_sel:WORD_0
s_waitcnt lgkmcnt(8)
v_smfmac_f32_16x16x64_bf16 v[104:107], v[4:7], v[24:31], v1
ds_read_b64 v[24:25], v150
ds_read_b64 v[26:27], v2
ds_read_b64 v[28:29], v151
ds_read_b64 v[30:31], v3
v_mfma_f32_32x32x16_bf16 v[192:207], v[56:59], v[232:235], v[192:207]
s_waitcnt vmcnt(8)
v_lshlrev_b32_sdwa v2, 3, v152 dst_sel:DWORD dst_unused:UNUSED_PAD src0_sel:DWORD src1_sel:WORD_1
v_lshlrev_b32_sdwa v152, 3, v152 dst_sel:DWORD dst_unused:UNUSED_PAD src0_sel:DWORD src1_sel:WORD_0
v_lshlrev_b32_sdwa v3, 3, v153 dst_sel:DWORD dst_unused:UNUSED_PAD src0_sel:DWORD src1_sel:WORD_1
v_lshlrev_b32_sdwa v153, 3, v153 dst_sel:DWORD dst_unused:UNUSED_PAD src0_sel:DWORD src1_sel:WORD_0
s_waitcnt lgkmcnt(8)
v_smfmac_f32_16x16x64_bf16 v[104:107], v[4:7], v[8:15], v1
ds_read_b64 v[8:9], v152
ds_read_b64 v[10:11], v2
ds_read_b64 v[12:13], v153
ds_read_b64 v[14:15], v3
v_mfma_f32_32x32x16_bf16 v[208:223], v[56:59], v[248:251], v[208:223]
v_lshlrev_b32_sdwa v2, 3, v154 dst_sel:DWORD dst_unused:UNUSED_PAD src0_sel:DWORD src1_sel:WORD_1
v_lshlrev_b32_sdwa v154, 3, v154 dst_sel:DWORD dst_unused:UNUSED_PAD src0_sel:DWORD src1_sel:WORD_0
v_lshlrev_b32_sdwa v3, 3, v155 dst_sel:DWORD dst_unused:UNUSED_PAD src0_sel:DWORD src1_sel:WORD_1
v_lshlrev_b32_sdwa v155, 3, v155 dst_sel:DWORD dst_unused:UNUSED_PAD src0_sel:DWORD src1_sel:WORD_0
s_waitcnt lgkmcnt(8)
v_smfmac_f32_16x16x64_bf16 v[104:107], v[4:7], v[16:23], v1
ds_read_b64 v[16:17], v154
ds_read_b64 v[18:19], v2
ds_read_b64 v[20:21], v155
ds_read_b64 v[22:23], v3
v_mfma_f32_32x32x16_bf16 v[192:207], v[60:63], v[236:239], v[192:207]
v_lshlrev_b32_sdwa v2, 3, v156 dst_sel:DWORD dst_unused:UNUSED_PAD src0_sel:DWORD src1_sel:WORD_1
v_lshlrev_b32_sdwa v156, 3, v156 dst_sel:DWORD dst_unused:UNUSED_PAD src0_sel:DWORD src1_sel:WORD_0
v_lshlrev_b32_sdwa v3, 3, v157 dst_sel:DWORD dst_unused:UNUSED_PAD src0_sel:DWORD src1_sel:WORD_1
v_lshlrev_b32_sdwa v157, 3, v157 dst_sel:DWORD dst_unused:UNUSED_PAD src0_sel:DWORD src1_sel:WORD_0
s_waitcnt lgkmcnt(8)
v_smfmac_f32_16x16x64_bf16 v[104:107], v[4:7], v[24:31], v1
ds_read_b64 v[24:25], v156
ds_read_b64 v[26:27], v2
ds_read_b64 v[28:29], v157
ds_read_b64 v[30:31], v3
v_mfma_f32_32x32x16_bf16 v[208:223], v[60:63], v[252:255], v[208:223]
v_lshlrev_b32_sdwa v2, 3, v158 dst_sel:DWORD dst_unused:UNUSED_PAD src0_sel:DWORD src1_sel:WORD_1
v_lshlrev_b32_sdwa v158, 3, v158 dst_sel:DWORD dst_unused:UNUSED_PAD src0_sel:DWORD src1_sel:WORD_0
v_lshlrev_b32_sdwa v3, 3, v159 dst_sel:DWORD dst_unused:UNUSED_PAD src0_sel:DWORD src1_sel:WORD_1
v_lshlrev_b32_sdwa v159, 3, v159 dst_sel:DWORD dst_unused:UNUSED_PAD src0_sel:DWORD src1_sel:WORD_0
s_waitcnt lgkmcnt(8)
v_smfmac_f32_16x16x64_bf16 v[108:111], v[4:7], v[8:15], v1
ds_read_b64 v[8:9], v158
ds_read_b64 v[10:11], v2
ds_read_b64 v[12:13], v159
ds_read_b64 v[14:15], v3
s_waitcnt vmcnt(6)
v_lshlrev_b32_sdwa v2, 3, v160 dst_sel:DWORD dst_unused:UNUSED_PAD src0_sel:DWORD src1_sel:WORD_1
v_lshlrev_b32_sdwa v160, 3, v160 dst_sel:DWORD dst_unused:UNUSED_PAD src0_sel:DWORD src1_sel:WORD_0
v_lshlrev_b32_sdwa v3, 3, v161 dst_sel:DWORD dst_unused:UNUSED_PAD src0_sel:DWORD src1_sel:WORD_1
v_lshlrev_b32_sdwa v161, 3, v161 dst_sel:DWORD dst_unused:UNUSED_PAD src0_sel:DWORD src1_sel:WORD_0
v_cvt_pk_bf16_f32 v144, v192, v208
v_cvt_pk_bf16_f32 v145, v193, v209
v_cvt_pk_bf16_f32 v146, v194, v210
v_cvt_pk_bf16_f32 v147, v195, v211
v_cvt_pk_bf16_f32 v148, v196, v212
v_cvt_pk_bf16_f32 v149, v197, v213
v_cvt_pk_bf16_f32 v150, v198, v214
v_cvt_pk_bf16_f32 v151, v199, v215
v_cvt_pk_bf16_f32 v152, v200, v216
v_cvt_pk_bf16_f32 v153, v201, v217
v_cvt_pk_bf16_f32 v154, v202, v218
v_cvt_pk_bf16_f32 v155, v203, v219
v_cvt_pk_bf16_f32 v156, v204, v220
v_cvt_pk_bf16_f32 v157, v205, v221
v_cvt_pk_bf16_f32 v158, v206, v222
v_cvt_pk_bf16_f32 v159, v207, v223
s_cmp_ge_u32 s3, 4
s_cbranch_scc1 d_join
s_mov_b32 s8, s32
s_mov_b32 s9, s33
s_mov_b32 s16, s42
s_mov_b32 s17, s43
s_waitcnt vmcnt(0)
v_mbcnt_lo_u32_b32 v192, -1, 0
v_mbcnt_hi_u32_b32 v192, -1, v192
s_cmp_eq_u32 s3, 0
s_cbranch_scc1 d_w0
s_cmp_eq_u32 s3, 3
s_cbranch_scc1 d_w3
v_lshrrev_b32 v193, 3, v192
v_mul_u32_u24 v193, 400, v193
v_and_b32 v192, 7, v192
v_lshl_add_u32 v192, v192, 4, v193
s_lshl_b32 s30, s3, 7
s_add_u32 s30, s30, s71
s_lshl_b32 s31, s3, 13
s_add_u32 m0, s31, 131072
s_nop 0
buffer_load_dwordx4 v192, s[8:11], s30 offen lds
s_add_u32 m0, m0, 1024
s_add_u32 s30, s30, 3200
buffer_load_dwordx4 v192, s[8:11], s30 offen lds
s_add_u32 m0, m0, 1024
s_add_u32 s30, s30, 3200
buffer_load_dwordx4 v192, s[8:11], s30 offen lds
s_add_u32 m0, m0, 1024
s_add_u32 s30, s30, 3200
buffer_load_dwordx4 v192, s[8:11], s30 offen lds
s_add_u32 m0, m0, 1024
s_add_u32 s30, s30, 3200
buffer_load_dwordx4 v192, s[8:11], s30 offen lds
s_add_u32 m0, m0, 1024
s_add_u32 s30, s30, 3200
buffer_load_dwordx4 v192, s[8:11], s30 offen lds
s_add_u32 m0, m0, 1024
s_add_u32 s30, s30, 3200
buffer_load_dwordx4 v192, s[8:11], s30 offen lds
s_add_u32 m0, m0, 1024
s_add_u32 s30, s30, 3200
buffer_load_dwordx4 v192, s[8:11], s30 offen lds
s_branch d_join
d_w3:
v_mul_u32_u24 v194, 400, v192
s_add_u32 s30, s71, 384
s_mov_b32 m0, 128064
s_nop 0
buffer_load_dwordx4 v194, s[8:11], s30 offen lds
v_lshrrev_b32 v193, 3, v192
v_and_b32 v192, 7, v192
v_lshlrev_b32 v192, 4, v192
v_lshl_or_b32 v192, v193, 9, v192
s_lshr_b32 s30, s27, 2
s_lshl_b32 s30, s30, 16
s_and_b32 s31, s27, 3
s_lshl_b32 s31, s31, 13
s_add_u32 s30, s30, s31
s_lshl_b32 s31, s26, 7
s_add_u32 s30, s30, s31
s_add_u32 s30, s30, 0x300000
s_mov_b32 m0, 159744
s_nop 0
buffer_load_dwordx4 v192, s[16:19], s30 offen lds
s_add_u32 m0, m0, 1024
s_add_u32 s30, s30, 4096
buffer_load_dwordx4 v192, s[16:19], s30 offen lds
s_add_u32 m0, m0, 1024
s_add_u32 s30, s30, 28672
buffer_load_dwordx4 v192, s[16:19], s30 offen lds
s_add_u32 m0, m0, 1024
s_add_u32 s30, s30, 4096
buffer_load_dwordx4 v192, s[16:19], s30 offen lds
s_branch d_join
d_w0:
v_and_b32 v193, 24, v192
v_and_b32 v194, 3, v192
v_lshl_add_u32 v193, v194, 1, v193
v_bfe_u32 v194, v192, 2, 1
v_add_u32 v193, v193, v194
v_lshlrev_b32 v193, 7, v193
v_lshrrev_b32 v194, 5, v192
v_lshl_add_u32 v194, v194, 4, v193
s_lshr_b32 s30, s27, 3
s_lshl_b32 s30, s30, 12
s_bfe_u32 s31, s27, 0x10002
s_lshl_b32 s31, s31, 15
s_add_u32 s30, s30, s31
s_and_b32 s31, s27, 3
s_lshl_b32 s31, s31, 5
s_mov_b32 m0, 131072
s_add_u32 s30, s30, s31
buffer_load_dwordx4 v194, s[12:15], s30 offen lds
s_mov_b32 s8, s36
s_mov_b32 s9, s37
s_mov_b32 s10, 0x68000
s_mov_b32 s11, 0x20000
s_lshr_b32 s30, s28, 2
s_lshl_b32 s30, s30, 8
s_and_b32 s31, s28, 3
s_lshl_b32 s31, s31, 4
s_add_u32 s30, s30, s31
s_mul_i32 s30, s30, 26
s_mov_b32 m0, 132096
v_lshrrev_b32 v193, 4, v192
v_mul_u32_u24 v193, 1664, v193
v_and_b32 v194, 15, v192
v_mul_u32_u24 v194, 28, v194
v_add_u32 v194, v194, v193
buffer_load_dword v194, s[8:11], s30 offen lds
v_lshrrev_b32 v193, 3, v192
v_and_b32 v192, 7, v192
v_lshlrev_b32 v192, 4, v192
v_lshl_or_b32 v192, v193, 9, v192
s_lshr_b32 s30, s27, 2
s_lshl_b32 s30, s30, 16
s_and_b32 s31, s27, 3
s_lshl_b32 s31, s31, 13
s_add_u32 s30, s30, s31
s_lshl_b32 s31, s26, 7
s_add_u32 s30, s30, s31
s_add_u32 s30, s30, 0x200000
s_mov_b32 m0, 155648
s_nop 0
buffer_load_dwordx4 v192, s[16:19], s30 offen lds
s_add_u32 m0, m0, 1024
s_add_u32 s30, s30, 4096
buffer_load_dwordx4 v192, s[16:19], s30 offen lds
s_add_u32 m0, m0, 1024
s_add_u32 s30, s30, 28672
buffer_load_dwordx4 v192, s[16:19], s30 offen lds
s_add_u32 m0, m0, 1024
s_add_u32 s30, s30, 4096
buffer_load_dwordx4 v192, s[16:19], s30 offen lds
d_join:
s_waitcnt lgkmcnt(8)
v_smfmac_f32_16x16x64_bf16 v[108:111], v[4:7], v[16:23], v1
ds_read_b64 v[16:17], v160
ds_read_b64 v[18:19], v2
ds_read_b64 v[20:21], v161
ds_read_b64 v[22:23], v3
v_mfma_f32_32x32x16_bf16 v[192:207], v[64:67], v[224:227], 0
v_lshlrev_b32_sdwa v2, 3, v162 dst_sel:DWORD dst_unused:UNUSED_PAD src0_sel:DWORD src1_sel:WORD_1
v_lshlrev_b32_sdwa v162, 3, v162 dst_sel:DWORD dst_unused:UNUSED_PAD src0_sel:DWORD src1_sel:WORD_0
v_lshlrev_b32_sdwa v3, 3, v163 dst_sel:DWORD dst_unused:UNUSED_PAD src0_sel:DWORD src1_sel:WORD_1
v_lshlrev_b32_sdwa v163, 3, v163 dst_sel:DWORD dst_unused:UNUSED_PAD src0_sel:DWORD src1_sel:WORD_0
s_waitcnt lgkmcnt(8)
v_smfmac_f32_16x16x64_bf16 v[108:111], v[4:7], v[24:31], v1
ds_read_b64 v[24:25], v162
ds_read_b64 v[26:27], v2
ds_read_b64 v[28:29], v163
ds_read_b64 v[30:31], v3
v_mfma_f32_32x32x16_bf16 v[208:223], v[64:67], v[240:243], 0
v_mfma_f32_32x32x16_bf16 v[192:207], v[68:71], v[228:231], v[192:207]
v_lshlrev_b32_sdwa v2, 3, v164 dst_sel:DWORD dst_unused:UNUSED_PAD src0_sel:DWORD src1_sel:WORD_1
v_lshlrev_b32_sdwa v164, 3, v164 dst_sel:DWORD dst_unused:UNUSED_PAD src0_sel:DWORD src1_sel:WORD_0
v_lshlrev_b32_sdwa v3, 3, v165 dst_sel:DWORD dst_unused:UNUSED_PAD src0_sel:DWORD src1_sel:WORD_1
v_lshlrev_b32_sdwa v165, 3, v165 dst_sel:DWORD dst_unused:UNUSED_PAD src0_sel:DWORD src1_sel:WORD_0
s_waitcnt lgkmcnt(8)
v_smfmac_f32_16x16x64_bf16 v[108:111], v[4:7], v[8:15], v1
ds_read_b64 v[8:9], v164
ds_read_b64 v[10:11], v2
ds_read_b64 v[12:13], v165
ds_read_b64 v[14:15], v3
v_mfma_f32_32x32x16_bf16 v[208:223], v[68:71], v[244:247], v[208:223]
v_lshlrev_b32_sdwa v2, 3, v166 dst_sel:DWORD dst_unused:UNUSED_PAD src0_sel:DWORD src1_sel:WORD_1
v_lshlrev_b32_sdwa v166, 3, v166 dst_sel:DWORD dst_unused:UNUSED_PAD src0_sel:DWORD src1_sel:WORD_0
v_lshlrev_b32_sdwa v3, 3, v167 dst_sel:DWORD dst_unused:UNUSED_PAD src0_sel:DWORD src1_sel:WORD_1
v_lshlrev_b32_sdwa v167, 3, v167 dst_sel:DWORD dst_unused:UNUSED_PAD src0_sel:DWORD src1_sel:WORD_0
s_waitcnt lgkmcnt(8)
v_smfmac_f32_16x16x64_bf16 v[112:115], v[4:7], v[16:23], v1
ds_read_b64 v[16:17], v166
ds_read_b64 v[18:19], v2
ds_read_b64 v[20:21], v167
ds_read_b64 v[22:23], v3
v_mfma_f32_32x32x16_bf16 v[192:207], v[72:75], v[232:235], v[192:207]
s_cmp_lt_u32 s3, 4
s_cbranch_scc1 1f
s_waitcnt vmcnt(4)
1:
v_lshlrev_b32_sdwa v2, 3, v168 dst_sel:DWORD dst_unused:UNUSED_PAD src0_sel:DWORD src1_sel:WORD_1
v_lshlrev_b32_sdwa v168, 3, v168 dst_sel:DWORD dst_unused:UNUSED_PAD src0_sel:DWORD src1_sel:WORD_0
v_lshlrev_b32_sdwa v3, 3, v169 dst_sel:DWORD dst_unused:UNUSED_PAD src0_sel:DWORD src1_sel:WORD_1
v_lshlrev_b32_sdwa v169, 3, v169 dst_sel:DWORD dst_unused:UNUSED_PAD src0_sel:DWORD src1_sel:WORD_0
s_waitcnt lgkmcnt(8)
v_smfmac_f32_16x16x64_bf16 v[112:115], v[4:7], v[24:31], v1
ds_read_b64 v[24:25], v168
ds_read_b64 v[26:27], v2
ds_read_b64 v[28:29], v169
ds_read_b64 v[30:31], v3
v_mfma_f32_32x32x16_bf16 v[208:223], v[72:75], v[248:251], v[208:223]
v_lshlrev_b32_sdwa v2, 3, v170 dst_sel:DWORD dst_unused:UNUSED_PAD src0_sel:DWORD src1_sel:WORD_1
v_lshlrev_b32_sdwa v170, 3, v170 dst_sel:DWORD dst_unused:UNUSED_PAD src0_sel:DWORD src1_sel:WORD_0
v_lshlrev_b32_sdwa v3, 3, v171 dst_sel:DWORD dst_unused:UNUSED_PAD src0_sel:DWORD src1_sel:WORD_1
v_lshlrev_b32_sdwa v171, 3, v171 dst_sel:DWORD dst_unused:UNUSED_PAD src0_sel:DWORD src1_sel:WORD_0
s_waitcnt lgkmcnt(8)
v_smfmac_f32_16x16x64_bf16 v[112:115], v[4:7], v[8:15], v1
ds_read_b64 v[8:9], v170
ds_read_b64 v[10:11], v2
ds_read_b64 v[12:13], v171
ds_read_b64 v[14:15], v3
v_mfma_f32_32x32x16_bf16 v[192:207], v[76:79], v[236:239], v[192:207]
v_lshlrev_b32_sdwa v2, 3, v172 dst_sel:DWORD dst_unused:UNUSED_PAD src0_sel:DWORD src1_sel:WORD_1
v_lshlrev_b32_sdwa v172, 3, v172 dst_sel:DWORD dst_unused:UNUSED_PAD src0_sel:DWORD src1_sel:WORD_0
v_lshlrev_b32_sdwa v3, 3, v173 dst_sel:DWORD dst_unused:UNUSED_PAD src0_sel:DWORD src1_sel:WORD_1
v_lshlrev_b32_sdwa v173, 3, v173 dst_sel:DWORD dst_unused:UNUSED_PAD src0_sel:DWORD src1_sel:WORD_0
s_waitcnt lgkmcnt(8)
v_smfmac_f32_16x16x64_bf16 v[112:115], v[4:7], v[16:23], v1
ds_read_b64 v[16:17], v172
ds_read_b64 v[18:19], v2
ds_read_b64 v[20:21], v173
ds_read_b64 v[22:23], v3
v_mfma_f32_32x32x16_bf16 v[208:223], v[76:79], v[252:255], v[208:223]
v_lshlrev_b32_sdwa v2, 3, v174 dst_sel:DWORD dst_unused:UNUSED_PAD src0_sel:DWORD src1_sel:WORD_1
v_lshlrev_b32_sdwa v174, 3, v174 dst_sel:DWORD dst_unused:UNUSED_PAD src0_sel:DWORD src1_sel:WORD_0
v_lshlrev_b32_sdwa v3, 3, v175 dst_sel:DWORD dst_unused:UNUSED_PAD src0_sel:DWORD src1_sel:WORD_1
v_lshlrev_b32_sdwa v175, 3, v175 dst_sel:DWORD dst_unused:UNUSED_PAD src0_sel:DWORD src1_sel:WORD_0
s_waitcnt lgkmcnt(8)
v_smfmac_f32_16x16x64_bf16 v[116:119], v[4:7], v[24:31], v1
ds_read_b64 v[24:25], v174
ds_read_b64 v[26:27], v2
ds_read_b64 v[28:29], v175
ds_read_b64 v[30:31], v3
s_cmp_lt_u32 s3, 4
s_cbranch_scc1 1f
s_waitcnt vmcnt(2)
1:
v_lshlrev_b32_sdwa v2, 3, v176 dst_sel:DWORD dst_unused:UNUSED_PAD src0_sel:DWORD src1_sel:WORD_1
v_lshlrev_b32_sdwa v176, 3, v176 dst_sel:DWORD dst_unused:UNUSED_PAD src0_sel:DWORD src1_sel:WORD_0
v_lshlrev_b32_sdwa v3, 3, v177 dst_sel:DWORD dst_unused:UNUSED_PAD src0_sel:DWORD src1_sel:WORD_1
v_lshlrev_b32_sdwa v177, 3, v177 dst_sel:DWORD dst_unused:UNUSED_PAD src0_sel:DWORD src1_sel:WORD_0
v_cvt_pk_bf16_f32 v160, v192, v208
v_cvt_pk_bf16_f32 v161, v193, v209
v_cvt_pk_bf16_f32 v162, v194, v210
v_cvt_pk_bf16_f32 v163, v195, v211
v_cvt_pk_bf16_f32 v164, v196, v212
v_cvt_pk_bf16_f32 v165, v197, v213
v_cvt_pk_bf16_f32 v166, v198, v214
v_cvt_pk_bf16_f32 v167, v199, v215
v_cvt_pk_bf16_f32 v168, v200, v216
v_cvt_pk_bf16_f32 v169, v201, v217
v_cvt_pk_bf16_f32 v170, v202, v218
v_cvt_pk_bf16_f32 v171, v203, v219
v_cvt_pk_bf16_f32 v172, v204, v220
v_cvt_pk_bf16_f32 v173, v205, v221
v_cvt_pk_bf16_f32 v174, v206, v222
v_cvt_pk_bf16_f32 v175, v207, v223
s_waitcnt lgkmcnt(8)
v_smfmac_f32_16x16x64_bf16 v[116:119], v[4:7], v[8:15], v1
ds_read_b64 v[8:9], v176
ds_read_b64 v[10:11], v2
ds_read_b64 v[12:13], v177
ds_read_b64 v[14:15], v3
v_mfma_f32_32x32x16_bf16 v[192:207], v[80:83], v[224:227], 0
v_lshlrev_b32_sdwa v2, 3, v178 dst_sel:DWORD dst_unused:UNUSED_PAD src0_sel:DWORD src1_sel:WORD_1
v_lshlrev_b32_sdwa v178, 3, v178 dst_sel:DWORD dst_unused:UNUSED_PAD src0_sel:DWORD src1_sel:WORD_0
v_lshlrev_b32_sdwa v3, 3, v179 dst_sel:DWORD dst_unused:UNUSED_PAD src0_sel:DWORD src1_sel:WORD_1
v_lshlrev_b32_sdwa v179, 3, v179 dst_sel:DWORD dst_unused:UNUSED_PAD src0_sel:DWORD src1_sel:WORD_0
s_waitcnt lgkmcnt(8)
v_smfmac_f32_16x16x64_bf16 v[116:119], v[4:7], v[16:23], v1
ds_read_b64 v[16:17], v178
ds_read_b64 v[18:19], v2
ds_read_b64 v[20:21], v179
ds_read_b64 v[22:23], v3
v_mfma_f32_32x32x16_bf16 v[208:223], v[80:83], v[240:243], 0
v_mfma_f32_32x32x16_bf16 v[192:207], v[84:87], v[228:231], v[192:207]
s_add_u32 s30, s21, 0
buffer_load_dwordx4 v[176:179], v0, s[4:7], s30 offen offset:0 sc1
v_lshlrev_b32_sdwa v2, 3, v180 dst_sel:DWORD dst_unused:UNUSED_PAD src0_sel:DWORD src1_sel:WORD_1
v_lshlrev_b32_sdwa v180, 3, v180 dst_sel:DWORD dst_unused:UNUSED_PAD src0_sel:DWORD src1_sel:WORD_0
v_lshlrev_b32_sdwa v3, 3, v181 dst_sel:DWORD dst_unused:UNUSED_PAD src0_sel:DWORD src1_sel:WORD_1
v_lshlrev_b32_sdwa v181, 3, v181 dst_sel:DWORD dst_unused:UNUSED_PAD src0_sel:DWORD src1_sel:WORD_0
s_waitcnt lgkmcnt(8)
v_smfmac_f32_16x16x64_bf16 v[116:119], v[4:7], v[24:31], v1
ds_read_b64 v[24:25], v180
ds_read_b64 v[26:27], v2
ds_read_b64 v[28:29], v181
ds_read_b64 v[30:31], v3
v_mfma_f32_32x32x16_bf16 v[208:223], v[84:87], v[244:247], v[208:223]
s_add_u32 s30, s21, 0
buffer_load_dwordx4 v[224:227], v0, s[4:7], s30 offen offset:512 sc1
v_lshlrev_b32_sdwa v2, 3, v182 dst_sel:DWORD dst_unused:UNUSED_PAD src0_sel:DWORD src1_sel:WORD_1
v_lshlrev_b32_sdwa v182, 3, v182 dst_sel:DWORD dst_unused:UNUSED_PAD src0_sel:DWORD src1_sel:WORD_0
v_lshlrev_b32_sdwa v3, 3, v183 dst_sel:DWORD dst_unused:UNUSED_PAD src0_sel:DWORD src1_sel:WORD_1
v_lshlrev_b32_sdwa v183, 3, v183 dst_sel:DWORD dst_unused:UNUSED_PAD src0_sel:DWORD src1_sel:WORD_0
s_waitcnt lgkmcnt(8)
v_smfmac_f32_16x16x64_bf16 v[120:123], v[4:7], v[8:15], v1
ds_read_b64 v[8:9], v182
ds_read_b64 v[10:11], v2
ds_read_b64 v[12:13], v183
ds_read_b64 v[14:15], v3
v_mfma_f32_32x32x16_bf16 v[192:207], v[88:91], v[232:235], v[192:207]
s_add_u32 s30, s21, 0
buffer_load_dwordx4 v[180:183], v0, s[4:7], s30 offen offset:128 sc1
s_cmp_lt_u32 s3, 4
s_cbranch_scc1 1f
s_waitcnt vmcnt(3)
1:
v_lshlrev_b32_sdwa v2, 3, v184 dst_sel:DWORD dst_unused:UNUSED_PAD src0_sel:DWORD src1_sel:WORD_1
v_lshlrev_b32_sdwa v184, 3, v184 dst_sel:DWORD dst_unused:UNUSED_PAD src0_sel:DWORD src1_sel:WORD_0
v_lshlrev_b32_sdwa v3, 3, v185 dst_sel:DWORD dst_unused:UNUSED_PAD src0_sel:DWORD src1_sel:WORD_1
v_lshlrev_b32_sdwa v185, 3, v185 dst_sel:DWORD dst_unused:UNUSED_PAD src0_sel:DWORD src1_sel:WORD_0
s_waitcnt lgkmcnt(8)
v_smfmac_f32_16x16x64_bf16 v[120:123], v[4:7], v[16:23], v1
ds_read_b64 v[16:17], v184
ds_read_b64 v[18:19], v2
ds_read_b64 v[20:21], v185
ds_read_b64 v[22:23], v3
v_mfma_f32_32x32x16_bf16 v[208:223], v[88:91], v[248:251], v[208:223]
s_add_u32 s30, s21, 0
buffer_load_dwordx4 v[240:243], v0, s[4:7], s30 offen offset:640 sc1
v_lshlrev_b32_sdwa v2, 3, v186 dst_sel:DWORD dst_unused:UNUSED_PAD src0_sel:DWORD src1_sel:WORD_1
v_lshlrev_b32_sdwa v186, 3, v186 dst_sel:DWORD dst_unused:UNUSED_PAD src0_sel:DWORD src1_sel:WORD_0
v_lshlrev_b32_sdwa v3, 3, v187 dst_sel:DWORD dst_unused:UNUSED_PAD src0_sel:DWORD src1_sel:WORD_1
v_lshlrev_b32_sdwa v187, 3, v187 dst_sel:DWORD dst_unused:UNUSED_PAD src0_sel:DWORD src1_sel:WORD_0
s_waitcnt lgkmcnt(8)
v_smfmac_f32_16x16x64_bf16 v[120:123], v[4:7], v[24:31], v1
ds_read_b64 v[24:25], v186
ds_read_b64 v[26:27], v2
ds_read_b64 v[28:29], v187
ds_read_b64 v[30:31], v3
v_mfma_f32_32x32x16_bf16 v[192:207], v[92:95], v[236:239], v[192:207]
s_add_u32 s30, s21, 0
buffer_load_dwordx4 v[184:187], v0, s[4:7], s30 offen offset:256 sc1
v_lshlrev_b32_sdwa v2, 3, v188 dst_sel:DWORD dst_unused:UNUSED_PAD src0_sel:DWORD src1_sel:WORD_1
v_lshlrev_b32_sdwa v188, 3, v188 dst_sel:DWORD dst_unused:UNUSED_PAD src0_sel:DWORD src1_sel:WORD_0
v_lshlrev_b32_sdwa v3, 3, v189 dst_sel:DWORD dst_unused:UNUSED_PAD src0_sel:DWORD src1_sel:WORD_1
v_lshlrev_b32_sdwa v189, 3, v189 dst_sel:DWORD dst_unused:UNUSED_PAD src0_sel:DWORD src1_sel:WORD_0
s_waitcnt lgkmcnt(8)
v_smfmac_f32_16x16x64_bf16 v[120:123], v[4:7], v[8:15], v1
ds_read_b64 v[8:9], v188
ds_read_b64 v[10:11], v2
ds_read_b64 v[12:13], v189
ds_read_b64 v[14:15], v3
v_mfma_f32_32x32x16_bf16 v[208:223], v[92:95], v[252:255], v[208:223]
s_add_u32 s30, s21, 0
buffer_load_dwordx4 v[228:231], v0, s[4:7], s30 offen offset:768 sc1
v_lshlrev_b32_sdwa v2, 3, v190 dst_sel:DWORD dst_unused:UNUSED_PAD src0_sel:DWORD src1_sel:WORD_1
v_lshlrev_b32_sdwa v190, 3, v190 dst_sel:DWORD dst_unused:UNUSED_PAD src0_sel:DWORD src1_sel:WORD_0
v_lshlrev_b32_sdwa v3, 3, v191 dst_sel:DWORD dst_unused:UNUSED_PAD src0_sel:DWORD src1_sel:WORD_1
v_lshlrev_b32_sdwa v191, 3, v191 dst_sel:DWORD dst_unused:UNUSED_PAD src0_sel:DWORD src1_sel:WORD_0
s_waitcnt lgkmcnt(8)
v_smfmac_f32_16x16x64_bf16 v[124:127], v[4:7], v[16:23], v1
ds_read_b64 v[16:17], v190
ds_read_b64 v[18:19], v2
ds_read_b64 v[20:21], v191
ds_read_b64 v[22:23], v3
s_add_u32 s30, s21, 0
buffer_load_dwordx4 v[188:191], v0, s[4:7], s30 offen offset:384 sc1
s_waitcnt vmcnt(4)
v_lshlrev_b32_sdwa v2, 3, v176 dst_sel:DWORD dst_unused:UNUSED_PAD src0_sel:DWORD src1_sel:WORD_1
v_lshlrev_b32_sdwa v176, 3, v176 dst_sel:DWORD dst_unused:UNUSED_PAD src0_sel:DWORD src1_sel:WORD_0
v_lshlrev_b32_sdwa v3, 3, v177 dst_sel:DWORD dst_unused:UNUSED_PAD src0_sel:DWORD src1_sel:WORD_1
v_lshlrev_b32_sdwa v177, 3, v177 dst_sel:DWORD dst_unused:UNUSED_PAD src0_sel:DWORD src1_sel:WORD_0
v_cvt_pk_bf16_f32 v192, v192, v208
v_cvt_pk_bf16_f32 v193, v193, v209
v_cvt_pk_bf16_f32 v194, v194, v210
v_cvt_pk_bf16_f32 v195, v195, v211
v_cvt_pk_bf16_f32 v196, v196, v212
v_cvt_pk_bf16_f32 v197, v197, v213
v_cvt_pk_bf16_f32 v198, v198, v214
v_cvt_pk_bf16_f32 v199, v199, v215
v_cvt_pk_bf16_f32 v200, v200, v216
v_cvt_pk_bf16_f32 v201, v201, v217
v_cvt_pk_bf16_f32 v202, v202, v218
v_cvt_pk_bf16_f32 v203, v203, v219
v_cvt_pk_bf16_f32 v204, v204, v220
v_cvt_pk_bf16_f32 v205, v205, v221
v_cvt_pk_bf16_f32 v206, v206, v222
v_cvt_pk_bf16_f32 v207, v207, v223
s_waitcnt lgkmcnt(8)
v_smfmac_f32_16x16x64_bf16 v[124:127], v[4:7], v[24:31], v1
ds_read_b64 v[24:25], v176
ds_read_b64 v[26:27], v2
ds_read_b64 v[28:29], v177
ds_read_b64 v[30:31], v3
s_add_u32 s30, s21, 0
buffer_load_dwordx4 v[244:247], v0, s[4:7], s30 offen offset:896 sc1
v_lshlrev_b32_sdwa v2, 3, v178 dst_sel:DWORD dst_unused:UNUSED_PAD src0_sel:DWORD src1_sel:WORD_1
v_lshlrev_b32_sdwa v178, 3, v178 dst_sel:DWORD dst_unused:UNUSED_PAD src0_sel:DWORD src1_sel:WORD_0
v_lshlrev_b32_sdwa v3, 3, v179 dst_sel:DWORD dst_unused:UNUSED_PAD src0_sel:DWORD src1_sel:WORD_1
v_lshlrev_b32_sdwa v179, 3, v179 dst_sel:DWORD dst_unused:UNUSED_PAD src0_sel:DWORD src1_sel:WORD_0
s_cmp_ge_u32 s3, 4
s_cbranch_scc1 g_join
v_mbcnt_lo_u32_b32 v56, -1, 0
v_mbcnt_hi_u32_b32 v56, -1, v56
s_waitcnt vmcnt(0)
s_cmp_eq_u32 s3, 0
s_cbranch_scc1 g_w0
s_cmp_eq_u32 s3, 3
s_cbranch_scc1 g_w3
s_lshl_b32 s25, s3, 1
s_lshr_b32 s70, s28, 3
s_mul_i32 s70, s70, 102400
s_add_u32 s70, s70, 0x10000
s_bfe_u32 s30, s28, 0x10002
s_lshl_b32 s30, s30, 13
s_add_u32 s70, s70, s30
s_and_b32 s30, s28, 3
s_lshl_b32 s30, s30, 8
s_add_u32 s70, s70, s30
s_lshl_b32 s30, s25, 14
s_add_u32 s70, s70, s30
s_add_u32 s71, s70, 16384
s_lshl_b32 s31, s3, 13
s_add_u32 s31, s31, 131072
v_and_b32 v57, 15, v56
v_lshl_add_u32 v56, v56, 7, s31
v_lshl_add_u32 v56, v57, 2, v56
v_xor_b32 v48, 1, v57
v_lshl_or_b32 v57, v48, 16, v57
v_xor_b32 v32, 0, v56
ds_read_b32 v32, v32 offset:0
v_xor_b32 v33, 4, v56
ds_read_b32 v33, v33 offset:0
v_xor_b32 v34, 8, v56
ds_read_b32 v34, v34 offset:0
v_xor_b32 v35, 12, v56
ds_read_b32 v35, v35 offset:0
v_xor_b32 v36, 16, v56
ds_read_b32 v36, v36 offset:0
v_xor_b32 v37, 20, v56
ds_read_b32 v37, v37 offset:0
v_xor_b32 v38, 24, v56
ds_read_b32 v38, v38 offset:0
v_xor_b32 v39, 28, v56
ds_read_b32 v39, v39 offset:0
v_xor_b32 v40, 32, v56
ds_read_b32 v40, v40 offset:0
v_xor_b32 v41, 36, v56
ds_read_b32 v41, v41 offset:0
v_xor_b32 v42, 40, v56
ds_read_b32 v42, v42 offset:0
v_xor_b32 v43, 44, v56
ds_read_b32 v43, v43 offset:0
v_xor_b32 v44, 48, v56
ds_read_b32 v44, v44 offset:0
v_xor_b32 v45, 52, v56
ds_read_b32 v45, v45 offset:0
v_xor_b32 v46, 56, v56
ds_read_b32 v46, v46 offset:0
v_xor_b32 v47, 60, v56
ds_read_b32 v47, v47 offset:0
v_xor_b32 v48, 0x0, v57
s_waitcnt lgkmcnt(14)
v_lshl_add_u32 v32, v33, 16, v32
v_lshl_add_u32 v48, v32, 4, v48
v_xor_b32 v49, 0x20002, v57
s_waitcnt lgkmcnt(12)
v_lshl_add_u32 v34, v35, 16, v34
v_lshl_add_u32 v49, v34, 4, v49
v_xor_b32 v50, 0x40004, v57
s_waitcnt lgkmcnt(10)
v_lshl_add_u32 v36, v37, 16, v36
v_lshl_add_u32 v50, v36, 4, v50
v_xor_b32 v51, 0x60006, v57
s_waitcnt lgkmcnt(8)
v_lshl_add_u32 v38, v39, 16, v38
v_lshl_add_u32 v51, v38, 4, v51
buffer_store_dwordx4 v[48:51], v0, s[4:7], s70 offen offset:0 sc1
v_xor_b32 v52, 0x80008, v57
s_waitcnt lgkmcnt(6)
v_lshl_add_u32 v40, v41, 16, v40
v_lshl_add_u32 v52, v40, 4, v52
v_xor_b32 v53, 0xa000a, v57
s_waitcnt lgkmcnt(4)
v_lshl_add_u32 v42, v43, 16, v42
v_lshl_add_u32 v53, v42, 4, v53
v_xor_b32 v54, 0xc000c, v57
s_waitcnt lgkmcnt(2)
v_lshl_add_u32 v44, v45, 16, v44
v_lshl_add_u32 v54, v44, 4, v54
v_xor_b32 v55, 0xe000e, v57
s_waitcnt lgkmcnt(0)
v_lshl_add_u32 v46, v47, 16, v46
v_lshl_add_u32 v55, v46, 4, v55
buffer_store_dwordx4 v[52:55], v0, s[4:7], s70 offen offset:128 sc1
v_xor_b32 v32, 0, v56
ds_read_b32 v32, v32 offset:64
v_xor_b32 v33, 4, v56
ds_read_b32 v33, v33 offset:64
v_xor_b32 v34, 8, v56
ds_read_b32 v34, v34 offset:64
v_xor_b32 v35, 12, v56
ds_read_b32 v35, v35 offset:64
v_xor_b32 v36, 16, v56
ds_read_b32 v36, v36 offset:64
v_xor_b32 v37, 20, v56
ds_read_b32 v37, v37 offset:64
v_xor_b32 v38, 24, v56
ds_read_b32 v38, v38 offset:64
v_xor_b32 v39, 28, v56
ds_read_b32 v39, v39 offset:64
v_xor_b32 v40, 32, v56
ds_read_b32 v40, v40 offset:64
v_xor_b32 v41, 36, v56
ds_read_b32 v41, v41 offset:64
v_xor_b32 v42, 40, v56
ds_read_b32 v42, v42 offset:64
v_xor_b32 v43, 44, v56
ds_read_b32 v43, v43 offset:64
v_xor_b32 v44, 48, v56
ds_read_b32 v44, v44 offset:64
v_xor_b32 v45, 52, v56
ds_read_b32 v45, v45 offset:64
v_xor_b32 v46, 56, v56
ds_read_b32 v46, v46 offset:64
v_xor_b32 v47, 60, v56
ds_read_b32 v47, v47 offset:64
v_xor_b32 v48, 0x0, v57
s_waitcnt lgkmcnt(14)
v_lshl_add_u32 v32, v33, 16, v32
v_lshl_add_u32 v48, v32, 4, v48
v_xor_b32 v49, 0x20002, v57
s_waitcnt lgkmcnt(12)
v_lshl_add_u32 v34, v35, 16, v34
v_lshl_add_u32 v49, v34, 4, v49
v_xor_b32 v50, 0x40004, v57
s_waitcnt lgkmcnt(10)
v_lshl_add_u32 v36, v37, 16, v36
v_lshl_add_u32 v50, v36, 4, v50
v_xor_b32 v51, 0x60006, v57
s_waitcnt lgkmcnt(8)
v_lshl_add_u32 v38, v39, 16, v38
v_lshl_add_u32 v51, v38, 4, v51
buffer_store_dwordx4 v[48:51], v0, s[4:7], s71 offen offset:0 sc1
v_xor_b32 v52, 0x80008, v57
s_waitcnt lgkmcnt(6)
v_lshl_add_u32 v40, v41, 16, v40
v_lshl_add_u32 v52, v40, 4, v52
v_xor_b32 v53, 0xa000a, v57
s_waitcnt lgkmcnt(4)
v_lshl_add_u32 v42, v43, 16, v42
v_lshl_add_u32 v53, v42, 4, v53
v_xor_b32 v54, 0xc000c, v57
s_waitcnt lgkmcnt(2)
v_lshl_add_u32 v44, v45, 16, v44
v_lshl_add_u32 v54, v44, 4, v54
v_xor_b32 v55, 0xe000e, v57
s_waitcnt lgkmcnt(0)
v_lshl_add_u32 v46, v47, 16, v46
v_lshl_add_u32 v55, v46, 4, v55
buffer_store_dwordx4 v[52:55], v0, s[4:7], s71 offen offset:128 sc1
s_branch g_join
g_w3:
v_lshlrev_b32 v57, 4, v56
v_add_u32 v57, 128064, v57
ds_read_b128 v[32:35], v57
s_lshr_b32 s70, s28, 3
s_mul_i32 s70, s70, 102400
s_add_u32 s70, s70, 0x28000
s_and_b32 s30, s28, 7
s_lshl_b32 s30, s30, 9
s_add_u32 s70, s70, s30
v_and_b32 v57, 31, v56
v_lshlrev_b32 v57, 4, v57
v_lshrrev_b32 v36, 5, v56
v_lshl_or_b32 v57, v36, 3, v57
s_mov_b32 s30, 0x40014000
s_mov_b32 s31, 0x40034002
s_waitcnt lgkmcnt(0)
v_lshl_add_u32 v32, v33, 16, v32
v_lshl_add_u32 v34, v35, 16, v34
v_lshl_add_u32 v32, v32, 2, s30
v_lshl_add_u32 v34, v34, 2, s31
v_and_b32 v33, 1, v56
v_lshlrev_b32 v33, 4, v33
v_and_b32 v35, 2, v56
v_cmp_ne_u32 vcc, 0, v35
v_alignbit_b32 v32, v32, v32, v33
v_alignbit_b32 v34, v34, v34, v33
v_cndmask_b32 v54, v32, v34, vcc
v_cndmask_b32 v55, v34, v32, vcc
buffer_store_dwordx2 v[54:55], v57, s[4:7], s70 offen sc1
s_cmp_ge_u32 s27, 8
s_cbranch_scc1 g_join
v_lshrrev_b32 v48, 2, v56
v_and_b32 v49, 1, v56
v_and_b32 v50, 2, v56
v_lshlrev_b32 v57, 3, v48
v_lshl_or_b32 v57, v49, 11, v57
v_lshl_or_b32 v57, v50, 9, v57
v_add_u32 v57, 159744, v57
ds_read_b64 v[32:33], v57 offset:0
ds_read_b64 v[34:35], v57 offset:128
ds_read_b64 v[36:37], v57 offset:256
ds_read_b64 v[38:39], v57 offset:384
ds_read_b64 v[40:41], v57 offset:512
ds_read_b64 v[42:43], v57 offset:640
ds_read_b64 v[44:45], v57 offset:768
ds_read_b64 v[46:47], v57 offset:896
v_mul_u32_u24 v48, 34816, v48
v_and_b32 v56, 3, v56
v_lshl_add_u32 v56, v56, 4, v48
s_mul_i32 s70, s26, 557056
s_lshr_b32 s30, s27, 2
s_lshl_b32 s30, s30, 10
s_add_u32 s70, s70, s30
s_and_b32 s30, s27, 3
s_lshl_b32 s30, s30, 7
s_add_u32 s70, s70, s30
s_add_u32 s70, s70, 0x348000
s_mov_b32 s30, 0x05040100
s_mov_b32 s31, 0x07060302
s_waitcnt lgkmcnt(0)
v_perm_b32 v48, v34, v32, s30
v_perm_b32 v49, v38, v36, s30
v_perm_b32 v50, v42, v40, s30
v_perm_b32 v51, v46, v44, s30
buffer_store_dwordx4 v[48:51], v56, s[4:7], s70 offen offset:0 sc1
v_perm_b32 v52, v34, v32, s31
v_perm_b32 v53, v38, v36, s31
v_perm_b32 v54, v42, v40, s31
v_perm_b32 v55, v46, v44, s31
buffer_store_dwordx4 v[52:55], v56, s[4:7], s70 offen offset:512 sc1
v_perm_b32 v48, v35, v33, s30
v_perm_b32 v49, v39, v37, s30
v_perm_b32 v50, v43, v41, s30
v_perm_b32 v51, v47, v45, s30
buffer_store_dwordx4 v[48:51], v56, s[4:7], s70 offen offset:64 sc1
v_perm_b32 v52, v35, v33, s31
v_perm_b32 v53, v39, v37, s31
v_perm_b32 v54, v43, v41, s31
v_perm_b32 v55, v47, v45, s31
buffer_store_dwordx4 v[52:55], v56, s[4:7], s70 offen offset:576 sc1
s_branch g_join
g_w0:
v_lshlrev_b32 v57, 4, v56
v_add_u32 v57, 131072, v57
ds_read_b128 v[60:63], v57
s_lshl_b32 s70, s26, 17
s_lshr_b32 s30, s27, 3
s_lshl_b32 s30, s30, 14
s_add_u32 s70, s70, s30
s_and_b32 s30, s27, 7
s_lshl_b32 s30, s30, 7
s_add_u32 s70, s70, s30
s_add_u32 s70, s70, 0x570000
s_add_u32 s71, s70, 8192
s_waitcnt lgkmcnt(0)
buffer_store_dwordx4 v[60:63], v0, s[4:7], s70 offen sc1
v_lshrrev_b32 v48, 2, v56
v_and_b32 v49, 1, v56
v_and_b32 v50, 2, v56
v_lshlrev_b32 v57, 3, v48
v_lshl_or_b32 v57, v49, 11, v57
v_lshl_or_b32 v57, v50, 9, v57
v_add_u32 v57, 155648, v57
ds_read_b64 v[32:33], v57 offset:0
ds_read_b64 v[34:35], v57 offset:128
ds_read_b64 v[36:37], v57 offset:256
ds_read_b64 v[38:39], v57 offset:384
ds_read_b64 v[40:41], v57 offset:512
ds_read_b64 v[42:43], v57 offset:640
ds_read_b64 v[44:45], v57 offset:768
ds_read_b64 v[46:47], v57 offset:896
v_mul_u32_u24 v48, 34816, v48
v_and_b32 v56, 3, v56
v_lshl_add_u32 v56, v56, 4, v48
s_mul_i32 s70, s26, 557056
s_lshr_b32 s30, s27, 2
s_lshl_b32 s30, s30, 10
s_add_u32 s70, s70, s30
s_and_b32 s30, s27, 3
s_lshl_b32 s30, s30, 7
s_add_u32 s70, s70, s30
s_add_u32 s70, s70, 0x344000
s_mov_b32 s30, 0x05040100
s_mov_b32 s31, 0x07060302
s_waitcnt lgkmcnt(0)
v_perm_b32 v48, v34, v32, s30
v_perm_b32 v49, v38, v36, s30
v_perm_b32 v50, v42, v40, s30
v_perm_b32 v51, v46, v44, s30
buffer_store_dwordx4 v[48:51], v56, s[4:7], s70 offen offset:0 sc1
v_perm_b32 v52, v34, v32, s31
v_perm_b32 v53, v38, v36, s31
v_perm_b32 v54, v42, v40, s31
v_perm_b32 v55, v46, v44, s31
buffer_store_dwordx4 v[52:55], v56, s[4:7], s70 offen offset:512 sc1
v_perm_b32 v48, v35, v33, s30
v_perm_b32 v49, v39, v37, s30
v_perm_b32 v50, v43, v41, s30
v_perm_b32 v51, v47, v45, s30
buffer_store_dwordx4 v[48:51], v56, s[4:7], s70 offen offset:64 sc1
v_perm_b32 v52, v35, v33, s31
v_perm_b32 v53, v39, v37, s31
v_perm_b32 v54, v43, v41, s31
v_perm_b32 v55, v47, v45, s31
buffer_store_dwordx4 v[52:55], v56, s[4:7], s70 offen offset:576 sc1
g_join:
s_waitcnt lgkmcnt(8)
v_smfmac_f32_16x16x64_bf16 v[124:127], v[4:7], v[8:15], v1
ds_read_b64 v[8:9], v178
ds_read_b64 v[10:11], v2
ds_read_b64 v[12:13], v179
ds_read_b64 v[14:15], v3
v_lshlrev_b32_sdwa v2, 3, v180 dst_sel:DWORD dst_unused:UNUSED_PAD src0_sel:DWORD src1_sel:WORD_1
v_lshlrev_b32_sdwa v180, 3, v180 dst_sel:DWORD dst_unused:UNUSED_PAD src0_sel:DWORD src1_sel:WORD_0
v_lshlrev_b32_sdwa v3, 3, v181 dst_sel:DWORD dst_unused:UNUSED_PAD src0_sel:DWORD src1_sel:WORD_1
v_lshlrev_b32_sdwa v181, 3, v181 dst_sel:DWORD dst_unused:UNUSED_PAD src0_sel:DWORD src1_sel:WORD_0
v_mov_b32 v32, 0
v_mov_b32 v33, 0
v_mov_b32 v34, 0
v_mov_b32 v35, 0
s_waitcnt lgkmcnt(8)
v_smfmac_f32_16x16x64_bf16 v[124:127], v[4:7], v[16:23], v1
ds_read_b64 v[16:17], v180
ds_read_b64 v[18:19], v2
ds_read_b64 v[20:21], v181
ds_read_b64 v[22:23], v3
s_add_u32 s30, s21, 8192
buffer_load_dwordx4 v[232:235], v0, s[4:7], s30 offen offset:0 sc1
v_lshlrev_b32_sdwa v2, 3, v182 dst_sel:DWORD dst_unused:UNUSED_PAD src0_sel:DWORD src1_sel:WORD_1
v_lshlrev_b32_sdwa v182, 3, v182 dst_sel:DWORD dst_unused:UNUSED_PAD src0_sel:DWORD src1_sel:WORD_0
v_lshlrev_b32_sdwa v3, 3, v183 dst_sel:DWORD dst_unused:UNUSED_PAD src0_sel:DWORD src1_sel:WORD_1
v_lshlrev_b32_sdwa v183, 3, v183 dst_sel:DWORD dst_unused:UNUSED_PAD src0_sel:DWORD src1_sel:WORD_0
s_waitcnt lgkmcnt(8)
v_smfmac_f32_16x16x64_bf16 v[32:35], v[4:7], v[24:31], v1
ds_read_b64 v[24:25], v182
ds_read_b64 v[26:27], v2
ds_read_b64 v[28:29], v183
ds_read_b64 v[30:31], v3
s_cmp_lt_u32 s3, 4
s_cbranch_scc1 1f
s_waitcnt vmcnt(2)
1:
v_lshlrev_b32_sdwa v2, 3, v184 dst_sel:DWORD dst_unused:UNUSED_PAD src0_sel:DWORD src1_sel:WORD_1
v_lshlrev_b32_sdwa v184, 3, v184 dst_sel:DWORD dst_unused:UNUSED_PAD src0_sel:DWORD src1_sel:WORD_0
v_lshlrev_b32_sdwa v3, 3, v185 dst_sel:DWORD dst_unused:UNUSED_PAD src0_sel:DWORD src1_sel:WORD_1
v_lshlrev_b32_sdwa v185, 3, v185 dst_sel:DWORD dst_unused:UNUSED_PAD src0_sel:DWORD src1_sel:WORD_0
s_waitcnt lgkmcnt(8)
v_smfmac_f32_16x16x64_bf16 v[32:35], v[4:7], v[8:15], v1
ds_read_b64 v[8:9], v184
ds_read_b64 v[10:11], v2
ds_read_b64 v[12:13], v185
ds_read_b64 v[14:15], v3
s_add_u32 s30, s21, 8192
buffer_load_dwordx4 v[248:251], v0, s[4:7], s30 offen offset:128 sc1
v_lshlrev_b32_sdwa v2, 3, v186 dst_sel:DWORD dst_unused:UNUSED_PAD src0_sel:DWORD src1_sel:WORD_1
v_lshlrev_b32_sdwa v186, 3, v186 dst_sel:DWORD dst_unused:UNUSED_PAD src0_sel:DWORD src1_sel:WORD_0
v_lshlrev_b32_sdwa v3, 3, v187 dst_sel:DWORD dst_unused:UNUSED_PAD src0_sel:DWORD src1_sel:WORD_1
v_lshlrev_b32_sdwa v187, 3, v187 dst_sel:DWORD dst_unused:UNUSED_PAD src0_sel:DWORD src1_sel:WORD_0
s_waitcnt lgkmcnt(8)
v_smfmac_f32_16x16x64_bf16 v[32:35], v[4:7], v[16:23], v1
ds_read_b64 v[16:17], v186
ds_read_b64 v[18:19], v2
ds_read_b64 v[20:21], v187
ds_read_b64 v[22:23], v3
v_lshlrev_b32_sdwa v2, 3, v188 dst_sel:DWORD dst_unused:UNUSED_PAD src0_sel:DWORD src1_sel:WORD_1
v_lshlrev_b32_sdwa v188, 3, v188 dst_sel:DWORD dst_unused:UNUSED_PAD src0_sel:DWORD src1_sel:WORD_0
v_lshlrev_b32_sdwa v3, 3, v189 dst_sel:DWORD dst_unused:UNUSED_PAD src0_sel:DWORD src1_sel:WORD_1
v_lshlrev_b32_sdwa v189, 3, v189 dst_sel:DWORD dst_unused:UNUSED_PAD src0_sel:DWORD src1_sel:WORD_0
v_mov_b32 v36, 0
v_mov_b32 v37, 0
v_mov_b32 v38, 0
v_mov_b32 v39, 0
s_waitcnt lgkmcnt(8)
v_smfmac_f32_16x16x64_bf16 v[32:35], v[4:7], v[24:31], v1
ds_read_b64 v[24:25], v188
ds_read_b64 v[26:27], v2
ds_read_b64 v[28:29], v189
ds_read_b64 v[30:31], v3
s_add_u32 s30, s21, 8192
buffer_load_dwordx4 v[236:239], v0, s[4:7], s30 offen offset:256 sc1
v_lshlrev_b32_sdwa v2, 3, v190 dst_sel:DWORD dst_unused:UNUSED_PAD src0_sel:DWORD src1_sel:WORD_1
v_lshlrev_b32_sdwa v190, 3, v190 dst_sel:DWORD dst_unused:UNUSED_PAD src0_sel:DWORD src1_sel:WORD_0
v_lshlrev_b32_sdwa v3, 3, v191 dst_sel:DWORD dst_unused:UNUSED_PAD src0_sel:DWORD src1_sel:WORD_1
v_lshlrev_b32_sdwa v191, 3, v191 dst_sel:DWORD dst_unused:UNUSED_PAD src0_sel:DWORD src1_sel:WORD_0
s_waitcnt lgkmcnt(8)
v_smfmac_f32_16x16x64_bf16 v[36:39], v[4:7], v[8:15], v1
ds_read_b64 v[8:9], v190
ds_read_b64 v[10:11], v2
ds_read_b64 v[12:13], v191
ds_read_b64 v[14:15], v3
s_cmp_lt_u32 s3, 4
s_cbranch_scc1 1f
s_waitcnt vmcnt(7)
1:
v_lshlrev_b32_sdwa v2, 3, v224 dst_sel:DWORD dst_unused:UNUSED_PAD src0_sel:DWORD src1_sel:WORD_1
v_lshlrev_b32_sdwa v224, 3, v224 dst_sel:DWORD dst_unused:UNUSED_PAD src0_sel:DWORD src1_sel:WORD_0
v_lshlrev_b32_sdwa v3, 3, v225 dst_sel:DWORD dst_unused:UNUSED_PAD src0_sel:DWORD src1_sel:WORD_1
v_lshlrev_b32_sdwa v225, 3, v225 dst_sel:DWORD dst_unused:UNUSED_PAD src0_sel:DWORD src1_sel:WORD_0
s_waitcnt lgkmcnt(8)
v_smfmac_f32_16x16x64_bf16 v[36:39], v[4:7], v[16:23], v1
ds_read_b64 v[16:17], v224
ds_read_b64 v[18:19], v2
ds_read_b64 v[20:21], v225
ds_read_b64 v[22:23], v3
s_add_u32 s30, s21, 8192
buffer_load_dwordx4 v[252:255], v0, s[4:7], s30 offen offset:384 sc1
v_lshlrev_b32_sdwa v2, 3, v226 dst_sel:DWORD dst_unused:UNUSED_PAD src0_sel:DWORD src1_sel:WORD_1
v_lshlrev_b32_sdwa v226, 3, v226 dst_sel:DWORD dst_unused:UNUSED_PAD src0_sel:DWORD src1_sel:WORD_0
v_lshlrev_b32_sdwa v3, 3, v227 dst_sel:DWORD dst_unused:UNUSED_PAD src0_sel:DWORD src1_sel:WORD_1
v_lshlrev_b32_sdwa v227, 3, v227 dst_sel:DWORD dst_unused:UNUSED_PAD src0_sel:DWORD src1_sel:WORD_0
s_cmp_ge_u32 s3, 4
s_cbranch_scc1 s_join
v_mov_b32 v60, 128000
v_mov_b32 v61, 1
s_mov_b64 exec, 1
s_waitcnt vmcnt(4)
ds_add_rtn_u32 v62, v60, v61
s_lshl_b32 s30, s28, 7
s_add_u32 s30, s30, 0x330000
v_mov_b32 v60, 0
v_mov_b32 v61, s29
s_waitcnt lgkmcnt(0)
v_readfirstlane_b32 s31, v62
s_nop 0
s_cmp_lg_u32 s31, 3
s_cbranch_scc1 1f
buffer_store_dword v61, v60, s[4:7], s30 offen sc1
1:
s_mov_b64 exec, -1
s_join:
s_waitcnt lgkmcnt(8)
v_smfmac_f32_16x16x64_bf16 v[36:39], v[4:7], v[24:31], v1
ds_read_b64 v[24:25], v226
ds_read_b64 v[26:27], v2
ds_read_b64 v[28:29], v227
ds_read_b64 v[30:31], v3
v_lshlrev_b32_sdwa v2, 3, v240 dst_sel:DWORD dst_unused:UNUSED_PAD src0_sel:DWORD src1_sel:WORD_1
v_lshlrev_b32_sdwa v240, 3, v240 dst_sel:DWORD dst_unused:UNUSED_PAD src0_sel:DWORD src1_sel:WORD_0
v_lshlrev_b32_sdwa v3, 3, v241 dst_sel:DWORD dst_unused:UNUSED_PAD src0_sel:DWORD src1_sel:WORD_1
v_lshlrev_b32_sdwa v241, 3, v241 dst_sel:DWORD dst_unused:UNUSED_PAD src0_sel:DWORD src1_sel:WORD_0
v_mov_b32 v40, 0
v_mov_b32 v41, 0
v_mov_b32 v42, 0
v_mov_b32 v43, 0
s_waitcnt lgkmcnt(8)
v_smfmac_f32_16x16x64_bf16 v[36:39], v[4:7], v[8:15], v1
ds_read_b64 v[8:9], v240
ds_read_b64 v[10:11], v2
ds_read_b64 v[12:13], v241
ds_read_b64 v[14:15], v3
s_add_u32 s30, s21, 8192
buffer_load_dwordx4 v[208:211], v0, s[4:7], s30 offen offset:512 sc1
v_lshlrev_b32_sdwa v2, 3, v242 dst_sel:DWORD dst_unused:UNUSED_PAD src0_sel:DWORD src1_sel:WORD_1
v_lshlrev_b32_sdwa v242, 3, v242 dst_sel:DWORD dst_unused:UNUSED_PAD src0_sel:DWORD src1_sel:WORD_0
v_lshlrev_b32_sdwa v3, 3, v243 dst_sel:DWORD dst_unused:UNUSED_PAD src0_sel:DWORD src1_sel:WORD_1
v_lshlrev_b32_sdwa v243, 3, v243 dst_sel:DWORD dst_unused:UNUSED_PAD src0_sel:DWORD src1_sel:WORD_0
s_waitcnt lgkmcnt(8)
v_smfmac_f32_16x16x64_bf16 v[40:43], v[4:7], v[16:23], v1
ds_read_b64 v[16:17], v242
ds_read_b64 v[18:19], v2
ds_read_b64 v[20:21], v243
ds_read_b64 v[22:23], v3
s_cmp_lt_u32 s3, 4
s_cbranch_scc1 1f
s_waitcnt vmcnt(5)
1:
v_lshlrev_b32_sdwa v2, 3, v228 dst_sel:DWORD dst_unused:UNUSED_PAD src0_sel:DWORD src1_sel:WORD_1
v_lshlrev_b32_sdwa v228, 3, v228 dst_sel:DWORD dst_unused:UNUSED_PAD src0_sel:DWORD src1_sel:WORD_0
v_lshlrev_b32_sdwa v3, 3, v229 dst_sel:DWORD dst_unused:UNUSED_PAD src0_sel:DWORD src1_sel:WORD_1
v_lshlrev_b32_sdwa v229, 3, v229 dst_sel:DWORD dst_unused:UNUSED_PAD src0_sel:DWORD src1_sel:WORD_0
s_waitcnt lgkmcnt(8)
v_smfmac_f32_16x16x64_bf16 v[40:43], v[4:7], v[24:31], v1
ds_read_b64 v[24:25], v228
ds_read_b64 v[26:27], v2
ds_read_b64 v[28:29], v229
ds_read_b64 v[30:31], v3
s_add_u32 s30, s21, 8192
buffer_load_dwordx4 v[212:215], v0, s[4:7], s30 offen offset:640 sc1
v_lshlrev_b32_sdwa v2, 3, v230 dst_sel:DWORD dst_unused:UNUSED_PAD src0_sel:DWORD src1_sel:WORD_1
v_lshlrev_b32_sdwa v230, 3, v230 dst_sel:DWORD dst_unused:UNUSED_PAD src0_sel:DWORD src1_sel:WORD_0
v_lshlrev_b32_sdwa v3, 3, v231 dst_sel:DWORD dst_unused:UNUSED_PAD src0_sel:DWORD src1_sel:WORD_1
v_lshlrev_b32_sdwa v231, 3, v231 dst_sel:DWORD dst_unused:UNUSED_PAD src0_sel:DWORD src1_sel:WORD_0
s_waitcnt lgkmcnt(8)
v_smfmac_f32_16x16x64_bf16 v[40:43], v[4:7], v[8:15], v1
ds_read_b64 v[8:9], v230
ds_read_b64 v[10:11], v2
ds_read_b64 v[12:13], v231
ds_read_b64 v[14:15], v3
v_lshlrev_b32_sdwa v2, 3, v244 dst_sel:DWORD dst_unused:UNUSED_PAD src0_sel:DWORD src1_sel:WORD_1
v_lshlrev_b32_sdwa v244, 3, v244 dst_sel:DWORD dst_unused:UNUSED_PAD src0_sel:DWORD src1_sel:WORD_0
v_lshlrev_b32_sdwa v3, 3, v245 dst_sel:DWORD dst_unused:UNUSED_PAD src0_sel:DWORD src1_sel:WORD_1
v_lshlrev_b32_sdwa v245, 3, v245 dst_sel:DWORD dst_unused:UNUSED_PAD src0_sel:DWORD src1_sel:WORD_0
v_mov_b32 v44, 0
v_mov_b32 v45, 0
v_mov_b32 v46, 0
v_mov_b32 v47, 0
s_waitcnt lgkmcnt(8)
v_smfmac_f32_16x16x64_bf16 v[40:43], v[4:7], v[16:23], v1
ds_read_b64 v[16:17], v244
ds_read_b64 v[18:19], v2
ds_read_b64 v[20:21], v245
ds_read_b64 v[22:23], v3
s_add_u32 s30, s21, 8192
buffer_load_dwordx4 v[216:219], v0, s[4:7], s30 offen offset:768 sc1
v_lshlrev_b32_sdwa v2, 3, v246 dst_sel:DWORD dst_unused:UNUSED_PAD src0_sel:DWORD src1_sel:WORD_1
v_lshlrev_b32_sdwa v246, 3, v246 dst_sel:DWORD dst_unused:UNUSED_PAD src0_sel:DWORD src1_sel:WORD_0
v_lshlrev_b32_sdwa v3, 3, v247 dst_sel:DWORD dst_unused:UNUSED_PAD src0_sel:DWORD src1_sel:WORD_1
v_lshlrev_b32_sdwa v247, 3, v247 dst_sel:DWORD dst_unused:UNUSED_PAD src0_sel:DWORD src1_sel:WORD_0
s_waitcnt lgkmcnt(8)
v_smfmac_f32_16x16x64_bf16 v[44:47], v[4:7], v[24:31], v1
ds_read_b64 v[24:25], v246
ds_read_b64 v[26:27], v2
ds_read_b64 v[28:29], v247
ds_read_b64 v[30:31], v3
s_waitcnt vmcnt(5)
v_lshlrev_b32_sdwa v2, 3, v232 dst_sel:DWORD dst_unused:UNUSED_PAD src0_sel:DWORD src1_sel:WORD_1
v_lshlrev_b32_sdwa v232, 3, v232 dst_sel:DWORD dst_unused:UNUSED_PAD src0_sel:DWORD src1_sel:WORD_0
v_lshlrev_b32_sdwa v3, 3, v233 dst_sel:DWORD dst_unused:UNUSED_PAD src0_sel:DWORD src1_sel:WORD_1
v_lshlrev_b32_sdwa v233, 3, v233 dst_sel:DWORD dst_unused:UNUSED_PAD src0_sel:DWORD src1_sel:WORD_0
s_waitcnt lgkmcnt(8)
v_smfmac_f32_16x16x64_bf16 v[44:47], v[4:7], v[8:15], v1
ds_read_b64 v[8:9], v232
ds_read_b64 v[10:11], v2
ds_read_b64 v[12:13], v233
ds_read_b64 v[14:15], v3
s_add_u32 s30, s21, 8192
buffer_load_dwordx4 v[220:223], v0, s[4:7], s30 offen offset:896 sc1
v_lshlrev_b32_sdwa v2, 3, v234 dst_sel:DWORD dst_unused:UNUSED_PAD src0_sel:DWORD src1_sel:WORD_1
v_lshlrev_b32_sdwa v234, 3, v234 dst_sel:DWORD dst_unused:UNUSED_PAD src0_sel:DWORD src1_sel:WORD_0
v_lshlrev_b32_sdwa v3, 3, v235 dst_sel:DWORD dst_unused:UNUSED_PAD src0_sel:DWORD src1_sel:WORD_1
v_lshlrev_b32_sdwa v235, 3, v235 dst_sel:DWORD dst_unused:UNUSED_PAD src0_sel:DWORD src1_sel:WORD_0
s_waitcnt lgkmcnt(8)
v_smfmac_f32_16x16x64_bf16 v[44:47], v[4:7], v[16:23], v1
ds_read_b64 v[16:17], v234
ds_read_b64 v[18:19], v2
ds_read_b64 v[20:21], v235
ds_read_b64 v[22:23], v3
v_lshlrev_b32_sdwa v2, 3, v248 dst_sel:DWORD dst_unused:UNUSED_PAD src0_sel:DWORD src1_sel:WORD_1
v_lshlrev_b32_sdwa v248, 3, v248 dst_sel:DWORD dst_unused:UNUSED_PAD src0_sel:DWORD src1_sel:WORD_0
v_lshlrev_b32_sdwa v3, 3, v249 dst_sel:DWORD dst_unused:UNUSED_PAD src0_sel:DWORD src1_sel:WORD_1
v_lshlrev_b32_sdwa v249, 3, v249 dst_sel:DWORD dst_unused:UNUSED_PAD src0_sel:DWORD src1_sel:WORD_0
v_mov_b32 v48, 0
v_mov_b32 v49, 0
v_mov_b32 v50, 0
v_mov_b32 v51, 0
s_waitcnt lgkmcnt(8)
v_smfmac_f32_16x16x64_bf16 v[44:47], v[4:7], v[24:31], v1
ds_read_b64 v[24:25], v248
ds_read_b64 v[26:27], v2
ds_read_b64 v[28:29], v249
ds_read_b64 v[30:31], v3
v_lshlrev_b32_sdwa v2, 3, v250 dst_sel:DWORD dst_unused:UNUSED_PAD src0_sel:DWORD src1_sel:WORD_1
v_lshlrev_b32_sdwa v250, 3, v250 dst_sel:DWORD dst_unused:UNUSED_PAD src0_sel:DWORD src1_sel:WORD_0
v_lshlrev_b32_sdwa v3, 3, v251 dst_sel:DWORD dst_unused:UNUSED_PAD src0_sel:DWORD src1_sel:WORD_1
v_lshlrev_b32_sdwa v251, 3, v251 dst_sel:DWORD dst_unused:UNUSED_PAD src0_sel:DWORD src1_sel:WORD_0
s_waitcnt lgkmcnt(8)
v_smfmac_f32_16x16x64_bf16 v[48:51], v[4:7], v[8:15], v1
ds_read_b64 v[8:9], v250
ds_read_b64 v[10:11], v2
ds_read_b64 v[12:13], v251
ds_read_b64 v[14:15], v3
s_waitcnt vmcnt(4)
v_lshlrev_b32_sdwa v2, 3, v236 dst_sel:DWORD dst_unused:UNUSED_PAD src0_sel:DWORD src1_sel:WORD_1
v_lshlrev_b32_sdwa v236, 3, v236 dst_sel:DWORD dst_unused:UNUSED_PAD src0_sel:DWORD src1_sel:WORD_0
v_lshlrev_b32_sdwa v3, 3, v237 dst_sel:DWORD dst_unused:UNUSED_PAD src0_sel:DWORD src1_sel:WORD_1
v_lshlrev_b32_sdwa v237, 3, v237 dst_sel:DWORD dst_unused:UNUSED_PAD src0_sel:DWORD src1_sel:WORD_0
s_waitcnt lgkmcnt(8)
v_smfmac_f32_16x16x64_bf16 v[48:51], v[4:7], v[16:23], v1
ds_read_b64 v[16:17], v236
ds_read_b64 v[18:19], v2
ds_read_b64 v[20:21], v237
ds_read_b64 v[22:23], v3
v_lshlrev_b32_sdwa v2, 3, v238 dst_sel:DWORD dst_unused:UNUSED_PAD src0_sel:DWORD src1_sel:WORD_1
v_lshlrev_b32_sdwa v238, 3, v238 dst_sel:DWORD dst_unused:UNUSED_PAD src0_sel:DWORD src1_sel:WORD_0
v_lshlrev_b32_sdwa v3, 3, v239 dst_sel:DWORD dst_unused:UNUSED_PAD src0_sel:DWORD src1_sel:WORD_1
v_lshlrev_b32_sdwa v239, 3, v239 dst_sel:DWORD dst_unused:UNUSED_PAD src0_sel:DWORD src1_sel:WORD_0
s_waitcnt lgkmcnt(8)
v_smfmac_f32_16x16x64_bf16 v[48:51], v[4:7], v[24:31], v1
ds_read_b64 v[24:25], v238
ds_read_b64 v[26:27], v2
ds_read_b64 v[28:29], v239
ds_read_b64 v[30:31], v3
v_lshlrev_b32_sdwa v2, 3, v252 dst_sel:DWORD dst_unused:UNUSED_PAD src0_sel:DWORD src1_sel:WORD_1
v_lshlrev_b32_sdwa v252, 3, v252 dst_sel:DWORD dst_unused:UNUSED_PAD src0_sel:DWORD src1_sel:WORD_0
v_lshlrev_b32_sdwa v3, 3, v253 dst_sel:DWORD dst_unused:UNUSED_PAD src0_sel:DWORD src1_sel:WORD_1
v_lshlrev_b32_sdwa v253, 3, v253 dst_sel:DWORD dst_unused:UNUSED_PAD src0_sel:DWORD src1_sel:WORD_0
v_mov_b32 v52, 0
v_mov_b32 v53, 0
v_mov_b32 v54, 0
v_mov_b32 v55, 0
s_waitcnt lgkmcnt(8)
v_smfmac_f32_16x16x64_bf16 v[48:51], v[4:7], v[8:15], v1
ds_read_b64 v[8:9], v252
ds_read_b64 v[10:11], v2
ds_read_b64 v[12:13], v253
ds_read_b64 v[14:15], v3
v_lshlrev_b32_sdwa v2, 3, v254 dst_sel:DWORD dst_unused:UNUSED_PAD src0_sel:DWORD src1_sel:WORD_1
v_lshlrev_b32_sdwa v254, 3, v254 dst_sel:DWORD dst_unused:UNUSED_PAD src0_sel:DWORD src1_sel:WORD_0
v_lshlrev_b32_sdwa v3, 3, v255 dst_sel:DWORD dst_unused:UNUSED_PAD src0_sel:DWORD src1_sel:WORD_1
v_lshlrev_b32_sdwa v255, 3, v255 dst_sel:DWORD dst_unused:UNUSED_PAD src0_sel:DWORD src1_sel:WORD_0
s_waitcnt lgkmcnt(8)
v_smfmac_f32_16x16x64_bf16 v[52:55], v[4:7], v[16:23], v1
ds_read_b64 v[16:17], v254
ds_read_b64 v[18:19], v2
ds_read_b64 v[20:21], v255
ds_read_b64 v[22:23], v3
s_waitcnt vmcnt(2)
v_lshlrev_b32_sdwa v2, 3, v208 dst_sel:DWORD dst_unused:UNUSED_PAD src0_sel:DWORD src1_sel:WORD_1
v_lshlrev_b32_sdwa v208, 3, v208 dst_sel:DWORD dst_unused:UNUSED_PAD src0_sel:DWORD src1_sel:WORD_0
v_lshlrev_b32_sdwa v3, 3, v209 dst_sel:DWORD dst_unused:UNUSED_PAD src0_sel:DWORD src1_sel:WORD_1
v_lshlrev_b32_sdwa v209, 3, v209 dst_sel:DWORD dst_unused:UNUSED_PAD src0_sel:DWORD src1_sel:WORD_0
s_waitcnt lgkmcnt(8)
v_smfmac_f32_16x16x64_bf16 v[52:55], v[4:7], v[24:31], v1
ds_read_b64 v[24:25], v208
ds_read_b64 v[26:27], v2
ds_read_b64 v[28:29], v209
ds_read_b64 v[30:31], v3
v_lshlrev_b32_sdwa v2, 3, v210 dst_sel:DWORD dst_unused:UNUSED_PAD src0_sel:DWORD src1_sel:WORD_1
v_lshlrev_b32_sdwa v210, 3, v210 dst_sel:DWORD dst_unused:UNUSED_PAD src0_sel:DWORD src1_sel:WORD_0
v_lshlrev_b32_sdwa v3, 3, v211 dst_sel:DWORD dst_unused:UNUSED_PAD src0_sel:DWORD src1_sel:WORD_1
v_lshlrev_b32_sdwa v211, 3, v211 dst_sel:DWORD dst_unused:UNUSED_PAD src0_sel:DWORD src1_sel:WORD_0
v_mbcnt_lo_u32_b32 v224, -1, 0
v_mbcnt_hi_u32_b32 v224, -1, v224
s_lshr_b32 s30, s27, 4
v_mov_b32 v225, s30
v_lshrrev_b32 v226, 3, v224
v_xor_b32 v226, s26, v226
v_cmp_gt_u32 vcc, 16, v224
v_and_b32 v224, 7, v224
s_lshl_b32 s70, s3, 10
v_cndmask_b32 v225, v225, v226, vcc
v_lshl_add_u32 v224, v225, 6, v224
v_lshlrev_b32 v224, 7, v224
s_add_u32 s70, s70, 0x330000
buffer_load_dword v225, v224, s[4:7], s70 offen sc1
s_waitcnt lgkmcnt(8)
v_smfmac_f32_16x16x64_bf16 v[52:55], v[4:7], v[8:15], v1
ds_read_b64 v[8:9], v210
ds_read_b64 v[10:11], v2
ds_read_b64 v[12:13], v211
ds_read_b64 v[14:15], v3
v_lshlrev_b32_sdwa v2, 3, v212 dst_sel:DWORD dst_unused:UNUSED_PAD src0_sel:DWORD src1_sel:WORD_1
v_lshlrev_b32_sdwa v212, 3, v212 dst_sel:DWORD dst_unused:UNUSED_PAD src0_sel:DWORD src1_sel:WORD_0
v_lshlrev_b32_sdwa v3, 3, v213 dst_sel:DWORD dst_unused:UNUSED_PAD src0_sel:DWORD src1_sel:WORD_1
v_lshlrev_b32_sdwa v213, 3, v213 dst_sel:DWORD dst_unused:UNUSED_PAD src0_sel:DWORD src1_sel:WORD_0
v_mov_b32 v56, 0
v_mov_b32 v57, 0
v_mov_b32 v58, 0
v_mov_b32 v59, 0
s_waitcnt lgkmcnt(8)
v_smfmac_f32_16x16x64_bf16 v[52:55], v[4:7], v[16:23], v1
ds_read_b64 v[16:17], v212
ds_read_b64 v[18:19], v2
ds_read_b64 v[20:21], v213
ds_read_b64 v[22:23], v3
v_lshlrev_b32_sdwa v2, 3, v214 dst_sel:DWORD dst_unused:UNUSED_PAD src0_sel:DWORD src1_sel:WORD_1
v_lshlrev_b32_sdwa v214, 3, v214 dst_sel:DWORD dst_unused:UNUSED_PAD src0_sel:DWORD src1_sel:WORD_0
v_lshlrev_b32_sdwa v3, 3, v215 dst_sel:DWORD dst_unused:UNUSED_PAD src0_sel:DWORD src1_sel:WORD_1
v_lshlrev_b32_sdwa v215, 3, v215 dst_sel:DWORD dst_unused:UNUSED_PAD src0_sel:DWORD src1_sel:WORD_0
s_waitcnt lgkmcnt(8)
v_smfmac_f32_16x16x64_bf16 v[56:59], v[4:7], v[24:31], v1
ds_read_b64 v[24:25], v214
ds_read_b64 v[26:27], v2
ds_read_b64 v[28:29], v215
ds_read_b64 v[30:31], v3
s_waitcnt vmcnt(1)
v_lshlrev_b32_sdwa v2, 3, v216 dst_sel:DWORD dst_unused:UNUSED_PAD src0_sel:DWORD src1_sel:WORD_1
v_lshlrev_b32_sdwa v216, 3, v216 dst_sel:DWORD dst_unused:UNUSED_PAD src0_sel:DWORD src1_sel:WORD_0
v_lshlrev_b32_sdwa v3, 3, v217 dst_sel:DWORD dst_unused:UNUSED_PAD src0_sel:DWORD src1_sel:WORD_1
v_lshlrev_b32_sdwa v217, 3, v217 dst_sel:DWORD dst_unused:UNUSED_PAD src0_sel:DWORD src1_sel:WORD_0
s_waitcnt lgkmcnt(8)
v_smfmac_f32_16x16x64_bf16 v[56:59], v[4:7], v[8:15], v1
ds_read_b64 v[8:9], v216
ds_read_b64 v[10:11], v2
ds_read_b64 v[12:13], v217
ds_read_b64 v[14:15], v3
v_lshlrev_b32_sdwa v2, 3, v218 dst_sel:DWORD dst_unused:UNUSED_PAD src0_sel:DWORD src1_sel:WORD_1
v_lshlrev_b32_sdwa v218, 3, v218 dst_sel:DWORD dst_unused:UNUSED_PAD src0_sel:DWORD src1_sel:WORD_0
v_lshlrev_b32_sdwa v3, 3, v219 dst_sel:DWORD dst_unused:UNUSED_PAD src0_sel:DWORD src1_sel:WORD_1
v_lshlrev_b32_sdwa v219, 3, v219 dst_sel:DWORD dst_unused:UNUSED_PAD src0_sel:DWORD src1_sel:WORD_0
s_waitcnt lgkmcnt(8)
v_smfmac_f32_16x16x64_bf16 v[56:59], v[4:7], v[16:23], v1
ds_read_b64 v[16:17], v218
ds_read_b64 v[18:19], v2
ds_read_b64 v[20:21], v219
ds_read_b64 v[22:23], v3
v_lshlrev_b32_sdwa v2, 3, v220 dst_sel:DWORD dst_unused:UNUSED_PAD src0_sel:DWORD src1_sel:WORD_1
v_lshlrev_b32_sdwa v220, 3, v220 dst_sel:DWORD dst_unused:UNUSED_PAD src0_sel:DWORD src1_sel:WORD_0
v_lshlrev_b32_sdwa v3, 3, v221 dst_sel:DWORD dst_unused:UNUSED_PAD src0_sel:DWORD src1_sel:WORD_1
v_lshlrev_b32_sdwa v221, 3, v221 dst_sel:DWORD dst_unused:UNUSED_PAD src0_sel:DWORD src1_sel:WORD_0
v_mov_b32 v60, 0
v_mov_b32 v61, 0
v_mov_b32 v62, 0
v_mov_b32 v63, 0
s_waitcnt lgkmcnt(8)
v_smfmac_f32_16x16x64_bf16 v[56:59], v[4:7], v[24:31], v1
ds_read_b64 v[24:25], v220
ds_read_b64 v[26:27], v2
ds_read_b64 v[28:29], v221
ds_read_b64 v[30:31], v3
v_lshlrev_b32_sdwa v2, 3, v222 dst_sel:DWORD dst_unused:UNUSED_PAD src0_sel:DWORD src1_sel:WORD_1
v_lshlrev_b32_sdwa v222, 3, v222 dst_sel:DWORD dst_unused:UNUSED_PAD src0_sel:DWORD src1_sel:WORD_0
v_lshlrev_b32_sdwa v3, 3, v223 dst_sel:DWORD dst_unused:UNUSED_PAD src0_sel:DWORD src1_sel:WORD_1
v_lshlrev_b32_sdwa v223, 3, v223 dst_sel:DWORD dst_unused:UNUSED_PAD src0_sel:DWORD src1_sel:WORD_0
s_waitcnt lgkmcnt(8)
v_smfmac_f32_16x16x64_bf16 v[60:63], v[4:7], v[8:15], v1
ds_read_b64 v[8:9], v222
ds_read_b64 v[10:11], v2
ds_read_b64 v[12:13], v223
ds_read_b64 v[14:15], v3
s_waitcnt lgkmcnt(8)
v_smfmac_f32_16x16x64_bf16 v[60:63], v[4:7], v[16:23], v1
s_waitcnt lgkmcnt(4)
v_smfmac_f32_16x16x64_bf16 v[60:63], v[4:7], v[24:31], v1
s_mov_b32 s31, 0
pb_loop:
s_waitcnt vmcnt(0)
v_cmp_ne_u32 vcc, s29, v225
s_cbranch_vccz pb_done
s_add_u32 s31, s31, 1
s_cmp_gt_u32 s31, 0x40000
s_cbranch_scc1 pb_done
s_sleep 8
buffer_load_dword v225, v224, s[4:7], s70 offen sc1
s_branch pb_loop
pb_done:
s_waitcnt lgkmcnt(0)
s_barrier
s_lshl_b32 s30, s27, 3
s_load_dwordx2 s[52:53], s[44:45], s30
s_load_dwordx2 s[58:59], s[46:47], s30
s_load_dwordx8 s[60:67], s[38:39], 0
s_load_dword s68, s[40:41], 0
s_load_dword s69, s[48:49], 0
s_lshr_b32 s54, s27, 4
s_lshl_b32 s54, s54, 3
s_add_u32 s54, s54, s3
s_lshl_b32 s54, s54, 14
s_add_u32 s54, s54, 0x570000
s_mov_b32 m0, s23
s_nop 0
s_add_u32 s30, s20, 32768
buffer_load_dwordx4 v[176:179], v0, s[4:7], s30 offen offset:0 sc1
ds_write_addtid_b32 v144 offset:32768
ds_write_addtid_b32 v145 offset:33024
ds_write_addtid_b32 v146 offset:33280
ds_write_addtid_b32 v147 offset:33536
s_add_u32 s30, s20, 32768
buffer_load_dwordx4 v[180:183], v0, s[4:7], s30 offen offset:128 sc1
ds_write_addtid_b32 v148 offset:33792
ds_write_addtid_b32 v149 offset:34048
ds_write_addtid_b32 v150 offset:34304
ds_write_addtid_b32 v151 offset:34560
ds_write_addtid_b32 v152 offset:34816
v_smfmac_f32_16x16x64_bf16 v[60:63], v[4:7], v[8:15], v1
ds_write_addtid_b32 v153 offset:35072
ds_write_addtid_b32 v154 offset:35328
ds_write_addtid_b32 v155 offset:35584
ds_write_addtid_b32 v156 offset:35840
ds_write_addtid_b32 v157 offset:36096
ds_write_addtid_b32 v158 offset:36352
ds_write_addtid_b32 v159 offset:36608
s_add_u32 s30, s20, 32768
buffer_load_dwordx4 v[184:187], v0, s[4:7], s30 offen offset:256 sc1
ds_write_addtid_b32 v128 offset:0
ds_write_addtid_b32 v129 offset:256
ds_write_addtid_b32 v130 offset:512
ds_write_addtid_b32 v131 offset:768
ds_write_addtid_b32 v132 offset:1024
ds_write_addtid_b32 v133 offset:1280
ds_write_addtid_b32 v134 offset:1536
ds_write_addtid_b32 v135 offset:1792
ds_write_addtid_b32 v136 offset:2048
ds_write_addtid_b32 v137 offset:2304
ds_write_addtid_b32 v138 offset:2560
ds_write_addtid_b32 v139 offset:2816
ds_write_addtid_b32 v140 offset:3072
ds_write_addtid_b32 v141 offset:3328
ds_write_addtid_b32 v142 offset:3584
ds_write_addtid_b32 v143 offset:3840
s_mov_b32 m0, s24
s_nop 0
s_add_u32 s30, s20, 32768
buffer_load_dwordx4 v[188:191], v0, s[4:7], s30 offen offset:384 sc1
ds_write_addtid_b32 v160 offset:28800
ds_write_addtid_b32 v161 offset:29056
ds_write_addtid_b32 v162 offset:29312
ds_write_addtid_b32 v163 offset:29568
ds_write_addtid_b32 v164 offset:29824
ds_write_addtid_b32 v165 offset:30080
ds_write_addtid_b32 v166 offset:30336
ds_write_addtid_b32 v167 offset:30592
ds_write_addtid_b32 v168 offset:30848
ds_write_addtid_b32 v169 offset:31104
ds_write_addtid_b32 v170 offset:31360
ds_write_addtid_b32 v171 offset:31616
ds_write_addtid_b32 v172 offset:31872
ds_write_addtid_b32 v173 offset:32128
ds_write_addtid_b32 v174 offset:32384
ds_write_addtid_b32 v175 offset:32640
ds_write_addtid_b32 v192 offset:61568
ds_write_addtid_b32 v193 offset:61824
ds_write_addtid_b32 v194 offset:62080
ds_write_addtid_b32 v195 offset:62336
ds_write_addtid_b32 v196 offset:62592
ds_write_addtid_b32 v197 offset:62848
ds_write_addtid_b32 v198 offset:63104
ds_write_addtid_b32 v199 offset:63360
ds_write_addtid_b32 v200 offset:63616
ds_write_addtid_b32 v201 offset:63872
ds_write_addtid_b32 v202 offset:64128
ds_write_addtid_b32 v203 offset:64384
ds_write_addtid_b32 v204 offset:64640
ds_write_addtid_b32 v205 offset:64896
ds_write_addtid_b32 v206 offset:65152
ds_write_addtid_b32 v207 offset:65408
s_waitcnt vmcnt(2)
v_lshlrev_b32_sdwa v2, 3, v176 dst_sel:DWORD dst_unused:UNUSED_PAD src0_sel:DWORD src1_sel:WORD_1
v_lshlrev_b32_sdwa v176, 3, v176 dst_sel:DWORD dst_unused:UNUSED_PAD src0_sel:DWORD src1_sel:WORD_0
v_lshlrev_b32_sdwa v3, 3, v177 dst_sel:DWORD dst_unused:UNUSED_PAD src0_sel:DWORD src1_sel:WORD_1
v_lshlrev_b32_sdwa v177, 3, v177 dst_sel:DWORD dst_unused:UNUSED_PAD src0_sel:DWORD src1_sel:WORD_0
s_waitcnt lgkmcnt(0)
s_barrier
ds_read_b64 v[8:9], v176
ds_read_b64 v[10:11], v2
ds_read_b64 v[12:13], v177
ds_read_b64 v[14:15], v3
s_add_u32 s30, s20, 32768
buffer_load_dwordx4 v[144:147], v0, s[4:7], s30 offen offset:512 sc1
v_lshlrev_b32_sdwa v2, 3, v178 dst_sel:DWORD dst_unused:UNUSED_PAD src0_sel:DWORD src1_sel:WORD_1
v_lshlrev_b32_sdwa v178, 3, v178 dst_sel:DWORD dst_unused:UNUSED_PAD src0_sel:DWORD src1_sel:WORD_0
v_lshlrev_b32_sdwa v3, 3, v179 dst_sel:DWORD dst_unused:UNUSED_PAD src0_sel:DWORD src1_sel:WORD_1
v_lshlrev_b32_sdwa v179, 3, v179 dst_sel:DWORD dst_unused:UNUSED_PAD src0_sel:DWORD src1_sel:WORD_0
ds_read_b64 v[16:17], v178
ds_read_b64 v[18:19], v2
ds_read_b64 v[20:21], v179
ds_read_b64 v[22:23], v3
s_add_u32 s30, s20, 32768
buffer_load_dwordx4 v[148:151], v0, s[4:7], s30 offen offset:640 sc1
v_lshlrev_b32_sdwa v2, 3, v180 dst_sel:DWORD dst_unused:UNUSED_PAD src0_sel:DWORD src1_sel:WORD_1
v_lshlrev_b32_sdwa v180, 3, v180 dst_sel:DWORD dst_unused:UNUSED_PAD src0_sel:DWORD src1_sel:WORD_0
v_lshlrev_b32_sdwa v3, 3, v181 dst_sel:DWORD dst_unused:UNUSED_PAD src0_sel:DWORD src1_sel:WORD_1
v_lshlrev_b32_sdwa v181, 3, v181 dst_sel:DWORD dst_unused:UNUSED_PAD src0_sel:DWORD src1_sel:WORD_0
ds_read_b64 v[24:25], v180
ds_read_b64 v[26:27], v2
ds_read_b64 v[28:29], v181
ds_read_b64 v[30:31], v3
v_mbcnt_lo_u32_b32 v241, -1, 0
v_mbcnt_hi_u32_b32 v241, -1, v241
v_and_b32 v240, 0x7f, v0
v_and_b32 v242, 4, v241
v_lshl_or_b32 v240, v242, 8, v240
v_and_b32 v242, 8, v241
v_lshl_or_b32 v240, v242, 6, v240
v_and_b32 v242, 16, v241
v_lshl_or_b32 v240, v242, 4, v240
s_and_b32 s31, s26, 1
s_lshl_b32 s31, s31, 13
s_sub_u32 s31, s22, s31
s_add_u32 s31, s31, 32768
buffer_load_dwordx4 v[224:227], v240, s[4:7], s31 offen offset:0 sc1
buffer_load_dwordx4 v[228:231], v240, s[4:7], s31 offen offset:128 sc1
v_lshlrev_b32_sdwa v2, 3, v182 dst_sel:DWORD dst_unused:UNUSED_PAD src0_sel:DWORD src1_sel:WORD_1
v_lshlrev_b32_sdwa v182, 3, v182 dst_sel:DWORD dst_unused:UNUSED_PAD src0_sel:DWORD src1_sel:WORD_0
v_lshlrev_b32_sdwa v3, 3, v183 dst_sel:DWORD dst_unused:UNUSED_PAD src0_sel:DWORD src1_sel:WORD_1
v_lshlrev_b32_sdwa v183, 3, v183 dst_sel:DWORD dst_unused:UNUSED_PAD src0_sel:DWORD src1_sel:WORD_0
s_waitcnt lgkmcnt(8)
v_smfmac_f32_16x16x64_bf16 v[96:99], v[4:7], v[8:15], v1
ds_read_b64 v[8:9], v182
ds_read_b64 v[10:11], v2
ds_read_b64 v[12:13], v183
ds_read_b64 v[14:15], v3
s_add_u32 s30, s20, 32768
buffer_load_dwordx4 v[152:155], v0, s[4:7], s30 offen offset:768 sc1
s_waitcnt vmcnt(5)
v_lshlrev_b32_sdwa v2, 3, v184 dst_sel:DWORD dst_unused:UNUSED_PAD src0_sel:DWORD src1_sel:WORD_1
v_lshlrev_b32_sdwa v184, 3, v184 dst_sel:DWORD dst_unused:UNUSED_PAD src0_sel:DWORD src1_sel:WORD_0
v_lshlrev_b32_sdwa v3, 3, v185 dst_sel:DWORD dst_unused:UNUSED_PAD src0_sel:DWORD src1_sel:WORD_1
v_lshlrev_b32_sdwa v185, 3, v185 dst_sel:DWORD dst_unused:UNUSED_PAD src0_sel:DWORD src1_sel:WORD_0
s_waitcnt lgkmcnt(8)
v_smfmac_f32_16x16x64_bf16 v[96:99], v[4:7], v[16:23], v1
ds_read_b64 v[16:17], v184
ds_read_b64 v[18:19], v2
ds_read_b64 v[20:21], v185
ds_read_b64 v[22:23], v3
s_add_u32 s30, s20, 32768
buffer_load_dwordx4 v[156:159], v0, s[4:7], s30 offen offset:896 sc1
v_lshlrev_b32_sdwa v2, 3, v186 dst_sel:DWORD dst_unused:UNUSED_PAD src0_sel:DWORD src1_sel:WORD_1
v_lshlrev_b32_sdwa v186, 3, v186 dst_sel:DWORD dst_unused:UNUSED_PAD src0_sel:DWORD src1_sel:WORD_0
v_lshlrev_b32_sdwa v3, 3, v187 dst_sel:DWORD dst_unused:UNUSED_PAD src0_sel:DWORD src1_sel:WORD_1
v_lshlrev_b32_sdwa v187, 3, v187 dst_sel:DWORD dst_unused:UNUSED_PAD src0_sel:DWORD src1_sel:WORD_0
s_waitcnt lgkmcnt(8)
v_smfmac_f32_16x16x64_bf16 v[96:99], v[4:7], v[24:31], v1
ds_read_b64 v[24:25], v186
ds_read_b64 v[26:27], v2
ds_read_b64 v[28:29], v187
ds_read_b64 v[30:31], v3
s_add_u32 s30, s20, 40960
buffer_load_dwordx4 v[160:163], v0, s[4:7], s30 offen offset:0 sc1
v_lshlrev_b32_sdwa v2, 3, v188 dst_sel:DWORD dst_unused:UNUSED_PAD src0_sel:DWORD src1_sel:WORD_1
v_lshlrev_b32_sdwa v188, 3, v188 dst_sel:DWORD dst_unused:UNUSED_PAD src0_sel:DWORD src1_sel:WORD_0
v_lshlrev_b32_sdwa v3, 3, v189 dst_sel:DWORD dst_unused:UNUSED_PAD src0_sel:DWORD src1_sel:WORD_1
v_lshlrev_b32_sdwa v189, 3, v189 dst_sel:DWORD dst_unused:UNUSED_PAD src0_sel:DWORD src1_sel:WORD_0
s_waitcnt lgkmcnt(8)
v_smfmac_f32_16x16x64_bf16 v[96:99], v[4:7], v[8:15], v1
ds_read_b64 v[8:9], v188
ds_read_b64 v[10:11], v2
ds_read_b64 v[12:13], v189
ds_read_b64 v[14:15], v3
s_add_u32 s30, s20, 40960
buffer_load_dwordx4 v[164:167], v0, s[4:7], s30 offen offset:128 sc1
v_lshlrev_b32_sdwa v2, 3, v190 dst_sel:DWORD dst_unused:UNUSED_PAD src0_sel:DWORD src1_sel:WORD_1
v_lshlrev_b32_sdwa v190, 3, v190 dst_sel:DWORD dst_unused:UNUSED_PAD src0_sel:DWORD src1_sel:WORD_0
v_lshlrev_b32_sdwa v3, 3, v191 dst_sel:DWORD dst_unused:UNUSED_PAD src0_sel:DWORD src1_sel:WORD_1
v_lshlrev_b32_sdwa v191, 3, v191 dst_sel:DWORD dst_unused:UNUSED_PAD src0_sel:DWORD src1_sel:WORD_0
s_waitcnt lgkmcnt(8)
v_smfmac_f32_16x16x64_bf16 v[100:103], v[4:7], v[16:23], v1
ds_read_b64 v[16:17], v190
ds_read_b64 v[18:19], v2
ds_read_b64 v[20:21], v191
ds_read_b64 v[22:23], v3
s_waitcnt vmcnt(6)
v_lshlrev_b32_sdwa v2, 3, v144 dst_sel:DWORD dst_unused:UNUSED_PAD src0_sel:DWORD src1_sel:WORD_1
v_lshlrev_b32_sdwa v144, 3, v144 dst_sel:DWORD dst_unused:UNUSED_PAD src0_sel:DWORD src1_sel:WORD_0
v_lshlrev_b32_sdwa v3, 3, v145 dst_sel:DWORD dst_unused:UNUSED_PAD src0_sel:DWORD src1_sel:WORD_1
v_lshlrev_b32_sdwa v145, 3, v145 dst_sel:DWORD dst_unused:UNUSED_PAD src0_sel:DWORD src1_sel:WORD_0
s_waitcnt lgkmcnt(8)
v_smfmac_f32_16x16x64_bf16 v[100:103], v[4:7], v[24:31], v1
ds_read_b64 v[24:25], v144
ds_read_b64 v[26:27], v2
ds_read_b64 v[28:29], v145
ds_read_b64 v[30:31], v3
s_add_u32 s30, s20, 40960
buffer_load_dwordx4 v[168:171], v0, s[4:7], s30 offen offset:256 sc1
v_lshlrev_b32_sdwa v2, 3, v146 dst_sel:DWORD dst_unused:UNUSED_PAD src0_sel:DWORD src1_sel:WORD_1
v_lshlrev_b32_sdwa v146, 3, v146 dst_sel:DWORD dst_unused:UNUSED_PAD src0_sel:DWORD src1_sel:WORD_0
v_lshlrev_b32_sdwa v3, 3, v147 dst_sel:DWORD dst_unused:UNUSED_PAD src0_sel:DWORD src1_sel:WORD_1
v_lshlrev_b32_sdwa v147, 3, v147 dst_sel:DWORD dst_unused:UNUSED_PAD src0_sel:DWORD src1_sel:WORD_0
s_waitcnt vmcnt(5)
v_permlane16_swap_b32 v224, v232
v_permlane16_swap_b32 v225, v233
v_permlane16_swap_b32 v226, v234
v_permlane16_swap_b32 v227, v235
v_permlane16_swap_b32 v228, v236
v_permlane16_swap_b32 v229, v237
v_permlane16_swap_b32 v230, v238
v_permlane16_swap_b32 v231, v239
s_waitcnt lgkmcnt(8)
v_smfmac_f32_16x16x64_bf16 v[100:103], v[4:7], v[8:15], v1
ds_read_b64 v[8:9], v146
ds_read_b64 v[10:11], v2
ds_read_b64 v[12:13], v147
ds_read_b64 v[14:15], v3
s_add_u32 s30, s20, 40960
buffer_load_dwordx4 v[172:175], v0, s[4:7], s30 offen offset:384 sc1
v_lshlrev_b32_sdwa v2, 3, v148 dst_sel:DWORD dst_unused:UNUSED_PAD src0_sel:DWORD src1_sel:WORD_1
v_lshlrev_b32_sdwa v148, 3, v148 dst_sel:DWORD dst_unused:UNUSED_PAD src0_sel:DWORD src1_sel:WORD_0
v_lshlrev_b32_sdwa v3, 3, v149 dst_sel:DWORD dst_unused:UNUSED_PAD src0_sel:DWORD src1_sel:WORD_1
v_lshlrev_b32_sdwa v149, 3, v149 dst_sel:DWORD dst_unused:UNUSED_PAD src0_sel:DWORD src1_sel:WORD_0
v_and_b32 v240, 24, v241
v_and_b32 v242, 3, v241
v_lshl_add_u32 v240, v242, 1, v240
v_bfe_u32 v242, v241, 2, 1
v_add_u32 v240, v240, v242
v_lshrrev_b32 v242, 5, v241
v_lshl_add_u32 v240, v240, 1, v242
s_lshl_b32 s30, s3, 10
s_add_u32 s30, s30, 131072
v_lshl_add_u32 v240, v240, 4, s30
s_waitcnt lgkmcnt(8)
v_smfmac_f32_16x16x64_bf16 v[100:103], v[4:7], v[16:23], v1
ds_read_b64 v[16:17], v148
ds_read_b64 v[18:19], v2
ds_read_b64 v[20:21], v149
ds_read_b64 v[22:23], v3
v_mfma_f32_32x32x16_bf16 v[192:207], v[224:227], v[64:67], 0
v_lshlrev_b32_sdwa v2, 3, v150 dst_sel:DWORD dst_unused:UNUSED_PAD src0_sel:DWORD src1_sel:WORD_1
v_lshlrev_b32_sdwa v150, 3, v150 dst_sel:DWORD dst_unused:UNUSED_PAD src0_sel:DWORD src1_sel:WORD_0
v_lshlrev_b32_sdwa v3, 3, v151 dst_sel:DWORD dst_unused:UNUSED_PAD src0_sel:DWORD src1_sel:WORD_1
v_lshlrev_b32_sdwa v151, 3, v151 dst_sel:DWORD dst_unused:UNUSED_PAD src0_sel:DWORD src1_sel:WORD_0
s_waitcnt lgkmcnt(8)
v_smfmac_f32_16x16x64_bf16 v[104:107], v[4:7], v[24:31], v1
ds_read_b64 v[24:25], v150
ds_read_b64 v[26:27], v2
ds_read_b64 v[28:29], v151
ds_read_b64 v[30:31], v3
v_mfma_f32_32x32x16_bf16 v[192:207], v[228:231], v[68:71], v[192:207]
s_add_u32 s30, s20, 40960
buffer_load_dwordx4 v[128:131], v0, s[4:7], s30 offen offset:512 sc1
s_waitcnt vmcnt(5)
v_lshlrev_b32_sdwa v2, 3, v152 dst_sel:DWORD dst_unused:UNUSED_PAD src0_sel:DWORD src1_sel:WORD_1
v_lshlrev_b32_sdwa v152, 3, v152 dst_sel:DWORD dst_unused:UNUSED_PAD src0_sel:DWORD src1_sel:WORD_0
v_lshlrev_b32_sdwa v3, 3, v153 dst_sel:DWORD dst_unused:UNUSED_PAD src0_sel:DWORD src1_sel:WORD_1
v_lshlrev_b32_sdwa v153, 3, v153 dst_sel:DWORD dst_unused:UNUSED_PAD src0_sel:DWORD src1_sel:WORD_0
s_waitcnt lgkmcnt(8)
v_smfmac_f32_16x16x64_bf16 v[104:107], v[4:7], v[8:15], v1
ds_read_b64 v[8:9], v152
ds_read_b64 v[10:11], v2
ds_read_b64 v[12:13], v153
ds_read_b64 v[14:15], v3
v_mfma_f32_32x32x16_bf16 v[192:207], v[232:235], v[72:75], v[192:207]
s_add_u32 s30, s20, 40960
buffer_load_dwordx4 v[132:135], v0, s[4:7], s30 offen offset:640 sc1
v_lshlrev_b32_sdwa v2, 3, v154 dst_sel:DWORD dst_unused:UNUSED_PAD src0_sel:DWORD src1_sel:WORD_1
v_lshlrev_b32_sdwa v154, 3, v154 dst_sel:DWORD dst_unused:UNUSED_PAD src0_sel:DWORD src1_sel:WORD_0
v_lshlrev_b32_sdwa v3, 3, v155 dst_sel:DWORD dst_unused:UNUSED_PAD src0_sel:DWORD src1_sel:WORD_1
v_lshlrev_b32_sdwa v155, 3, v155 dst_sel:DWORD dst_unused:UNUSED_PAD src0_sel:DWORD src1_sel:WORD_0
s_waitcnt lgkmcnt(8)
v_smfmac_f32_16x16x64_bf16 v[104:107], v[4:7], v[16:23], v1
ds_read_b64 v[16:17], v154
ds_read_b64 v[18:19], v2
ds_read_b64 v[20:21], v155
ds_read_b64 v[22:23], v3
v_mfma_f32_32x32x16_bf16 v[192:207], v[236:239], v[76:79], v[192:207]
v_lshlrev_b32_sdwa v2, 3, v156 dst_sel:DWORD dst_unused:UNUSED_PAD src0_sel:DWORD src1_sel:WORD_1
v_lshlrev_b32_sdwa v156, 3, v156 dst_sel:DWORD dst_unused:UNUSED_PAD src0_sel:DWORD src1_sel:WORD_0
v_lshlrev_b32_sdwa v3, 3, v157 dst_sel:DWORD dst_unused:UNUSED_PAD src0_sel:DWORD src1_sel:WORD_1
v_lshlrev_b32_sdwa v157, 3, v157 dst_sel:DWORD dst_unused:UNUSED_PAD src0_sel:DWORD src1_sel:WORD_0
s_waitcnt lgkmcnt(8)
v_smfmac_f32_16x16x64_bf16 v[104:107], v[4:7], v[24:31], v1
ds_read_b64 v[24:25], v156
ds_read_b64 v[26:27], v2
ds_read_b64 v[28:29], v157
ds_read_b64 v[30:31], v3
v_mfma_f32_32x32x16_bf16 v[208:223], v[224:227], v[80:83], 0
s_add_u32 s30, s20, 40960
buffer_load_dwordx4 v[136:139], v0, s[4:7], s30 offen offset:768 sc1
v_lshlrev_b32_sdwa v2, 3, v158 dst_sel:DWORD dst_unused:UNUSED_PAD src0_sel:DWORD src1_sel:WORD_1
v_lshlrev_b32_sdwa v158, 3, v158 dst_sel:DWORD dst_unused:UNUSED_PAD src0_sel:DWORD src1_sel:WORD_0
v_lshlrev_b32_sdwa v3, 3, v159 dst_sel:DWORD dst_unused:UNUSED_PAD src0_sel:DWORD src1_sel:WORD_1
v_lshlrev_b32_sdwa v159, 3, v159 dst_sel:DWORD dst_unused:UNUSED_PAD src0_sel:DWORD src1_sel:WORD_0
s_waitcnt lgkmcnt(8)
v_smfmac_f32_16x16x64_bf16 v[108:111], v[4:7], v[8:15], v1
ds_read_b64 v[8:9], v158
ds_read_b64 v[10:11], v2
ds_read_b64 v[12:13], v159
ds_read_b64 v[14:15], v3
v_mfma_f32_32x32x16_bf16 v[208:223], v[228:231], v[84:87], v[208:223]
s_add_u32 s30, s20, 40960
buffer_load_dwordx4 v[140:143], v0, s[4:7], s30 offen offset:896 sc1
s_waitcnt vmcnt(6)
v_lshlrev_b32_sdwa v2, 3, v160 dst_sel:DWORD dst_unused:UNUSED_PAD src0_sel:DWORD src1_sel:WORD_1
v_lshlrev_b32_sdwa v160, 3, v160 dst_sel:DWORD dst_unused:UNUSED_PAD src0_sel:DWORD src1_sel:WORD_0
v_lshlrev_b32_sdwa v3, 3, v161 dst_sel:DWORD dst_unused:UNUSED_PAD src0_sel:DWORD src1_sel:WORD_1
v_lshlrev_b32_sdwa v161, 3, v161 dst_sel:DWORD dst_unused:UNUSED_PAD src0_sel:DWORD src1_sel:WORD_0
v_cvt_pk_bf16_f32 v192, v192, v196
v_cvt_pk_bf16_f32 v193, v193, v197
v_cvt_pk_bf16_f32 v194, v194, v198
v_cvt_pk_bf16_f32 v195, v195, v199
ds_write_b128 v240, v[192:195] offset:16384
s_waitcnt lgkmcnt(8)
v_smfmac_f32_16x16x64_bf16 v[108:111], v[4:7], v[16:23], v1
ds_read_b64 v[16:17], v160
ds_read_b64 v[18:19], v2
ds_read_b64 v[20:21], v161
ds_read_b64 v[22:23], v3
v_mfma_f32_32x32x16_bf16 v[208:223], v[232:235], v[88:91], v[208:223]
s_add_u32 s30, s21, 32768
buffer_load_dwordx4 v[176:179], v0, s[4:7], s30 offen offset:0 sc1
v_lshlrev_b32_sdwa v2, 3, v162 dst_sel:DWORD dst_unused:UNUSED_PAD src0_sel:DWORD src1_sel:WORD_1
v_lshlrev_b32_sdwa v162, 3, v162 dst_sel:DWORD dst_unused:UNUSED_PAD src0_sel:DWORD src1_sel:WORD_0
v_lshlrev_b32_sdwa v3, 3, v163 dst_sel:DWORD dst_unused:UNUSED_PAD src0_sel:DWORD src1_sel:WORD_1
v_lshlrev_b32_sdwa v163, 3, v163 dst_sel:DWORD dst_unused:UNUSED_PAD src0_sel:DWORD src1_sel:WORD_0
s_waitcnt lgkmcnt(8)
v_smfmac_f32_16x16x64_bf16 v[108:111], v[4:7], v[24:31], v1
ds_read_b64 v[24:25], v162
ds_read_b64 v[26:27], v2
ds_read_b64 v[28:29], v163
ds_read_b64 v[30:31], v3
v_mfma_f32_32x32x16_bf16 v[208:223], v[236:239], v[92:95], v[208:223]
s_add_u32 s30, s21, 32768
buffer_load_dwordx4 v[180:183], v0, s[4:7], s30 offen offset:128 sc1
v_lshlrev_b32_sdwa v2, 3, v164 dst_sel:DWORD dst_unused:UNUSED_PAD src0_sel:DWORD src1_sel:WORD_1
v_lshlrev_b32_sdwa v164, 3, v164 dst_sel:DWORD dst_unused:UNUSED_PAD src0_sel:DWORD src1_sel:WORD_0
v_lshlrev_b32_sdwa v3, 3, v165 dst_sel:DWORD dst_unused:UNUSED_PAD src0_sel:DWORD src1_sel:WORD_1
v_lshlrev_b32_sdwa v165, 3, v165 dst_sel:DWORD dst_unused:UNUSED_PAD src0_sel:DWORD src1_sel:WORD_0
s_waitcnt lgkmcnt(8)
v_smfmac_f32_16x16x64_bf16 v[108:111], v[4:7], v[8:15], v1
ds_read_b64 v[8:9], v164
ds_read_b64 v[10:11], v2
ds_read_b64 v[12:13], v165
ds_read_b64 v[14:15], v3
s_add_u32 s30, s21, 32768
buffer_load_dwordx4 v[184:187], v0, s[4:7], s30 offen offset:256 sc1
v_lshlrev_b32_sdwa v2, 3, v166 dst_sel:DWORD dst_unused:UNUSED_PAD src0_sel:DWORD src1_sel:WORD_1
v_lshlrev_b32_sdwa v166, 3, v166 dst_sel:DWORD dst_unused:UNUSED_PAD src0_sel:DWORD src1_sel:WORD_0
v_lshlrev_b32_sdwa v3, 3, v167 dst_sel:DWORD dst_unused:UNUSED_PAD src0_sel:DWORD src1_sel:WORD_1
v_lshlrev_b32_sdwa v167, 3, v167 dst_sel:DWORD dst_unused:UNUSED_PAD src0_sel:DWORD src1_sel:WORD_0
s_waitcnt lgkmcnt(8)
v_smfmac_f32_16x16x64_bf16 v[112:115], v[4:7], v[16:23], v1
ds_read_b64 v[16:17], v166
ds_read_b64 v[18:19], v2
ds_read_b64 v[20:21], v167
ds_read_b64 v[22:23], v3
s_add_u32 s30, s21, 32768
buffer_load_dwordx4 v[188:191], v0, s[4:7], s30 offen offset:384 sc1
s_waitcnt vmcnt(8)
v_lshlrev_b32_sdwa v2, 3, v168 dst_sel:DWORD dst_unused:UNUSED_PAD src0_sel:DWORD src1_sel:WORD_1
v_lshlrev_b32_sdwa v168, 3, v168 dst_sel:DWORD dst_unused:UNUSED_PAD src0_sel:DWORD src1_sel:WORD_0
v_lshlrev_b32_sdwa v3, 3, v169 dst_sel:DWORD dst_unused:UNUSED_PAD src0_sel:DWORD src1_sel:WORD_1
v_lshlrev_b32_sdwa v169, 3, v169 dst_sel:DWORD dst_unused:UNUSED_PAD src0_sel:DWORD src1_sel:WORD_0
v_cvt_pk_bf16_f32 v208, v208, v212
v_cvt_pk_bf16_f32 v209, v209, v213
v_cvt_pk_bf16_f32 v210, v210, v214
v_cvt_pk_bf16_f32 v211, v211, v215
ds_write_b128 v240, v[208:211] offset:24576
s_waitcnt lgkmcnt(8)
v_smfmac_f32_16x16x64_bf16 v[112:115], v[4:7], v[24:31], v1
ds_read_b64 v[24:25], v168
ds_read_b64 v[26:27], v2
ds_read_b64 v[28:29], v169
ds_read_b64 v[30:31], v3
s_add_u32 s30, s22, 16384
buffer_load_dwordx4 v[224:227], v0, s[4:7], s30 offen offset:0 sc1
v_lshlrev_b32_sdwa v2, 3, v170 dst_sel:DWORD dst_unused:UNUSED_PAD src0_sel:DWORD src1_sel:WORD_1
v_lshlrev_b32_sdwa v170, 3, v170 dst_sel:DWORD dst_unused:UNUSED_PAD src0_sel:DWORD src1_sel:WORD_0
v_lshlrev_b32_sdwa v3, 3, v171 dst_sel:DWORD dst_unused:UNUSED_PAD src0_sel:DWORD src1_sel:WORD_1
v_lshlrev_b32_sdwa v171, 3, v171 dst_sel:DWORD dst_unused:UNUSED_PAD src0_sel:DWORD src1_sel:WORD_0
s_waitcnt lgkmcnt(8)
v_smfmac_f32_16x16x64_bf16 v[112:115], v[4:7], v[8:15], v1
ds_read_b64 v[8:9], v170
ds_read_b64 v[10:11], v2
ds_read_b64 v[12:13], v171
ds_read_b64 v[14:15], v3
s_add_u32 s30, s22, 16384
buffer_load_dwordx4 v[240:243], v0, s[4:7], s30 offen offset:512 sc1
v_lshlrev_b32_sdwa v2, 3, v172 dst_sel:DWORD dst_unused:UNUSED_PAD src0_sel:DWORD src1_sel:WORD_1
v_lshlrev_b32_sdwa v172, 3, v172 dst_sel:DWORD dst_unused:UNUSED_PAD src0_sel:DWORD src1_sel:WORD_0
v_lshlrev_b32_sdwa v3, 3, v173 dst_sel:DWORD dst_unused:UNUSED_PAD src0_sel:DWORD src1_sel:WORD_1
v_lshlrev_b32_sdwa v173, 3, v173 dst_sel:DWORD dst_unused:UNUSED_PAD src0_sel:DWORD src1_sel:WORD_0
s_waitcnt lgkmcnt(8)
v_smfmac_f32_16x16x64_bf16 v[112:115], v[4:7], v[16:23], v1
ds_read_b64 v[16:17], v172
ds_read_b64 v[18:19], v2
ds_read_b64 v[20:21], v173
ds_read_b64 v[22:23], v3
s_add_u32 s30, s22, 16384
buffer_load_dwordx4 v[228:231], v0, s[4:7], s30 offen offset:128 sc1
v_lshlrev_b32_sdwa v2, 3, v174 dst_sel:DWORD dst_unused:UNUSED_PAD src0_sel:DWORD src1_sel:WORD_1
v_lshlrev_b32_sdwa v174, 3, v174 dst_sel:DWORD dst_unused:UNUSED_PAD src0_sel:DWORD src1_sel:WORD_0
v_lshlrev_b32_sdwa v3, 3, v175 dst_sel:DWORD dst_unused:UNUSED_PAD src0_sel:DWORD src1_sel:WORD_1
v_lshlrev_b32_sdwa v175, 3, v175 dst_sel:DWORD dst_unused:UNUSED_PAD src0_sel:DWORD src1_sel:WORD_0
s_waitcnt lgkmcnt(8)
v_smfmac_f32_16x16x64_bf16 v[116:119], v[4:7], v[24:31], v1
ds_read_b64 v[24:25], v174
ds_read_b64 v[26:27], v2
ds_read_b64 v[28:29], v175
ds_read_b64 v[30:31], v3
s_add_u32 s30, s22, 16384
buffer_load_dwordx4 v[244:247], v0, s[4:7], s30 offen offset:640 sc1
s_waitcnt vmcnt(10)
v_lshlrev_b32_sdwa v2, 3, v128 dst_sel:DWORD dst_unused:UNUSED_PAD src0_sel:DWORD src1_sel:WORD_1
v_lshlrev_b32_sdwa v128, 3, v128 dst_sel:DWORD dst_unused:UNUSED_PAD src0_sel:DWORD src1_sel:WORD_0
v_lshlrev_b32_sdwa v3, 3, v129 dst_sel:DWORD dst_unused:UNUSED_PAD src0_sel:DWORD src1_sel:WORD_1
v_lshlrev_b32_sdwa v129, 3, v129 dst_sel:DWORD dst_unused:UNUSED_PAD src0_sel:DWORD src1_sel:WORD_0
s_waitcnt lgkmcnt(8)
v_smfmac_f32_16x16x64_bf16 v[116:119], v[4:7], v[8:15], v1
ds_read_b64 v[8:9], v128
ds_read_b64 v[10:11], v2
ds_read_b64 v[12:13], v129
ds_read_b64 v[14:15], v3
s_add_u32 s30, s22, 16384
buffer_load_dwordx4 v[232:235], v0, s[4:7], s30 offen offset:256 sc1
v_lshlrev_b32_sdwa v2, 3, v130 dst_sel:DWORD dst_unused:UNUSED_PAD src0_sel:DWORD src1_sel:WORD_1
v_lshlrev_b32_sdwa v130, 3, v130 dst_sel:DWORD dst_unused:UNUSED_PAD src0_sel:DWORD src1_sel:WORD_0
v_lshlrev_b32_sdwa v3, 3, v131 dst_sel:DWORD dst_unused:UNUSED_PAD src0_sel:DWORD src1_sel:WORD_1
v_lshlrev_b32_sdwa v131, 3, v131 dst_sel:DWORD dst_unused:UNUSED_PAD src0_sel:DWORD src1_sel:WORD_0
s_waitcnt lgkmcnt(8)
v_smfmac_f32_16x16x64_bf16 v[116:119], v[4:7], v[16:23], v1
ds_read_b64 v[16:17], v130
ds_read_b64 v[18:19], v2
ds_read_b64 v[20:21], v131
ds_read_b64 v[22:23], v3
s_add_u32 s30, s22, 16384
buffer_load_dwordx4 v[248:251], v0, s[4:7], s30 offen offset:768 sc1
v_lshlrev_b32_sdwa v2, 3, v132 dst_sel:DWORD dst_unused:UNUSED_PAD src0_sel:DWORD src1_sel:WORD_1
v_lshlrev_b32_sdwa v132, 3, v132 dst_sel:DWORD dst_unused:UNUSED_PAD src0_sel:DWORD src1_sel:WORD_0
v_lshlrev_b32_sdwa v3, 3, v133 dst_sel:DWORD dst_unused:UNUSED_PAD src0_sel:DWORD src1_sel:WORD_1
v_lshlrev_b32_sdwa v133, 3, v133 dst_sel:DWORD dst_unused:UNUSED_PAD src0_sel:DWORD src1_sel:WORD_0
s_waitcnt lgkmcnt(8)
v_smfmac_f32_16x16x64_bf16 v[116:119], v[4:7], v[24:31], v1
ds_read_b64 v[24:25], v132
ds_read_b64 v[26:27], v2
ds_read_b64 v[28:29], v133
ds_read_b64 v[30:31], v3
s_add_u32 s30, s22, 16384
buffer_load_dwordx4 v[236:239], v0, s[4:7], s30 offen offset:384 sc1
v_lshlrev_b32_sdwa v2, 3, v134 dst_sel:DWORD dst_unused:UNUSED_PAD src0_sel:DWORD src1_sel:WORD_1
v_lshlrev_b32_sdwa v134, 3, v134 dst_sel:DWORD dst_unused:UNUSED_PAD src0_sel:DWORD src1_sel:WORD_0
v_lshlrev_b32_sdwa v3, 3, v135 dst_sel:DWORD dst_unused:UNUSED_PAD src0_sel:DWORD src1_sel:WORD_1
v_lshlrev_b32_sdwa v135, 3, v135 dst_sel:DWORD dst_unused:UNUSED_PAD src0_sel:DWORD src1_sel:WORD_0
s_waitcnt lgkmcnt(8)
v_smfmac_f32_16x16x64_bf16 v[120:123], v[4:7], v[8:15], v1
ds_read_b64 v[8:9], v134
ds_read_b64 v[10:11], v2
ds_read_b64 v[12:13], v135
ds_read_b64 v[14:15], v3
s_add_u32 s30, s22, 16384
buffer_load_dwordx4 v[252:255], v0, s[4:7], s30 offen offset:896 sc1
s_waitcnt vmcnt(12)
v_lshlrev_b32_sdwa v2, 3, v136 dst_sel:DWORD dst_unused:UNUSED_PAD src0_sel:DWORD src1_sel:WORD_1
v_lshlrev_b32_sdwa v136, 3, v136 dst_sel:DWORD dst_unused:UNUSED_PAD src0_sel:DWORD src1_sel:WORD_0
v_lshlrev_b32_sdwa v3, 3, v137 dst_sel:DWORD dst_unused:UNUSED_PAD src0_sel:DWORD src1_sel:WORD_1
v_lshlrev_b32_sdwa v137, 3, v137 dst_sel:DWORD dst_unused:UNUSED_PAD src0_sel:DWORD src1_sel:WORD_0
s_waitcnt lgkmcnt(8)
v_smfmac_f32_16x16x64_bf16 v[120:123], v[4:7], v[16:23], v1
ds_read_b64 v[16:17], v136
ds_read_b64 v[18:19], v2
ds_read_b64 v[20:21], v137
ds_read_b64 v[22:23], v3
v_lshlrev_b32_sdwa v2, 3, v138 dst_sel:DWORD dst_unused:UNUSED_PAD src0_sel:DWORD src1_sel:WORD_1
v_lshlrev_b32_sdwa v138, 3, v138 dst_sel:DWORD dst_unused:UNUSED_PAD src0_sel:DWORD src1_sel:WORD_0
v_lshlrev_b32_sdwa v3, 3, v139 dst_sel:DWORD dst_unused:UNUSED_PAD src0_sel:DWORD src1_sel:WORD_1
v_lshlrev_b32_sdwa v139, 3, v139 dst_sel:DWORD dst_unused:UNUSED_PAD src0_sel:DWORD src1_sel:WORD_0
s_waitcnt lgkmcnt(8)
v_smfmac_f32_16x16x64_bf16 v[120:123], v[4:7], v[24:31], v1
ds_read_b64 v[24:25], v138
ds_read_b64 v[26:27], v2
ds_read_b64 v[28:29], v139
ds_read_b64 v[30:31], v3
v_lshlrev_b32_sdwa v2, 3, v140 dst_sel:DWORD dst_unused:UNUSED_PAD src0_sel:DWORD src1_sel:WORD_1
v_lshlrev_b32_sdwa v140, 3, v140 dst_sel:DWORD dst_unused:UNUSED_PAD src0_sel:DWORD src1_sel:WORD_0
v_lshlrev_b32_sdwa v3, 3, v141 dst_sel:DWORD dst_unused:UNUSED_PAD src0_sel:DWORD src1_sel:WORD_1
v_lshlrev_b32_sdwa v141, 3, v141 dst_sel:DWORD dst_unused:UNUSED_PAD src0_sel:DWORD src1_sel:WORD_0
s_waitcnt lgkmcnt(8)
v_smfmac_f32_16x16x64_bf16 v[120:123], v[4:7], v[8:15], v1
ds_read_b64 v[8:9], v140
ds_read_b64 v[10:11], v2
ds_read_b64 v[12:13], v141
ds_read_b64 v[14:15], v3
s_add_u32 s30, s21, 32768
buffer_load_dwordx4 v[144:147], v0, s[4:7], s30 offen offset:512 sc1
v_lshlrev_b32_sdwa v2, 3, v142 dst_sel:DWORD dst_unused:UNUSED_PAD src0_sel:DWORD src1_sel:WORD_1
v_lshlrev_b32_sdwa v142, 3, v142 dst_sel:DWORD dst_unused:UNUSED_PAD src0_sel:DWORD src1_sel:WORD_0
v_lshlrev_b32_sdwa v3, 3, v143 dst_sel:DWORD dst_unused:UNUSED_PAD src0_sel:DWORD src1_sel:WORD_1
v_lshlrev_b32_sdwa v143, 3, v143 dst_sel:DWORD dst_unused:UNUSED_PAD src0_sel:DWORD src1_sel:WORD_0
s_waitcnt lgkmcnt(8)
v_smfmac_f32_16x16x64_bf16 v[124:127], v[4:7], v[16:23], v1
ds_read_b64 v[16:17], v142
ds_read_b64 v[18:19], v2
ds_read_b64 v[20:21], v143
ds_read_b64 v[22:23], v3
s_add_u32 s30, s21, 32768
buffer_load_dwordx4 v[148:151], v0, s[4:7], s30 offen offset:640 sc1
s_waitcnt vmcnt(12)
v_lshlrev_b32_sdwa v2, 3, v176 dst_sel:DWORD dst_unused:UNUSED_PAD src0_sel:DWORD src1_sel:WORD_1
v_lshlrev_b32_sdwa v176, 3, v176 dst_sel:DWORD dst_unused:UNUSED_PAD src0_sel:DWORD src1_sel:WORD_0
v_lshlrev_b32_sdwa v3, 3, v177 dst_sel:DWORD dst_unused:UNUSED_PAD src0_sel:DWORD src1_sel:WORD_1
v_lshlrev_b32_sdwa v177, 3, v177 dst_sel:DWORD dst_unused:UNUSED_PAD src0_sel:DWORD src1_sel:WORD_0
s_waitcnt lgkmcnt(8)
v_smfmac_f32_16x16x64_bf16 v[124:127], v[4:7], v[24:31], v1
ds_read_b64 v[24:25], v176
ds_read_b64 v[26:27], v2
ds_read_b64 v[28:29], v177
ds_read_b64 v[30:31], v3
s_waitcnt vmcnt(8)
v_mfma_f32_32x32x16_bf16 v[192:207], v[64:67], v[224:227], 0
s_add_u32 s30, s21, 32768
buffer_load_dwordx4 v[152:155], v0, s[4:7], s30 offen offset:768 sc1
v_lshlrev_b32_sdwa v2, 3, v178 dst_sel:DWORD dst_unused:UNUSED_PAD src0_sel:DWORD src1_sel:WORD_1
v_lshlrev_b32_sdwa v178, 3, v178 dst_sel:DWORD dst_unused:UNUSED_PAD src0_sel:DWORD src1_sel:WORD_0
v_lshlrev_b32_sdwa v3, 3, v179 dst_sel:DWORD dst_unused:UNUSED_PAD src0_sel:DWORD src1_sel:WORD_1
v_lshlrev_b32_sdwa v179, 3, v179 dst_sel:DWORD dst_unused:UNUSED_PAD src0_sel:DWORD src1_sel:WORD_0
s_waitcnt lgkmcnt(8)
v_smfmac_f32_16x16x64_bf16 v[124:127], v[4:7], v[8:15], v1
ds_read_b64 v[8:9], v178
ds_read_b64 v[10:11], v2
ds_read_b64 v[12:13], v179
ds_read_b64 v[14:15], v3
v_mfma_f32_32x32x16_bf16 v[208:223], v[64:67], v[240:243], 0
s_waitcnt vmcnt(7)
v_mfma_f32_32x32x16_bf16 v[192:207], v[68:71], v[228:231], v[192:207]
s_add_u32 s30, s21, 32768
buffer_load_dwordx4 v[156:159], v0, s[4:7], s30 offen offset:896 sc1
v_lshlrev_b32_sdwa v2, 3, v180 dst_sel:DWORD dst_unused:UNUSED_PAD src0_sel:DWORD src1_sel:WORD_1
v_lshlrev_b32_sdwa v180, 3, v180 dst_sel:DWORD dst_unused:UNUSED_PAD src0_sel:DWORD src1_sel:WORD_0
v_lshlrev_b32_sdwa v3, 3, v181 dst_sel:DWORD dst_unused:UNUSED_PAD src0_sel:DWORD src1_sel:WORD_1
v_lshlrev_b32_sdwa v181, 3, v181 dst_sel:DWORD dst_unused:UNUSED_PAD src0_sel:DWORD src1_sel:WORD_0
s_waitcnt lgkmcnt(8)
v_smfmac_f32_16x16x64_bf16 v[124:127], v[4:7], v[16:23], v1
ds_read_b64 v[16:17], v180
ds_read_b64 v[18:19], v2
ds_read_b64 v[20:21], v181
ds_read_b64 v[22:23], v3
v_mfma_f32_32x32x16_bf16 v[208:223], v[68:71], v[244:247], v[208:223]
s_add_u32 s30, s21, 40960
buffer_load_dwordx4 v[160:163], v0, s[4:7], s30 offen offset:0 sc1
v_lshlrev_b32_sdwa v2, 3, v182 dst_sel:DWORD dst_unused:UNUSED_PAD src0_sel:DWORD src1_sel:WORD_1
v_lshlrev_b32_sdwa v182, 3, v182 dst_sel:DWORD dst_unused:UNUSED_PAD src0_sel:DWORD src1_sel:WORD_0
v_lshlrev_b32_sdwa v3, 3, v183 dst_sel:DWORD dst_unused:UNUSED_PAD src0_sel:DWORD src1_sel:WORD_1
v_lshlrev_b32_sdwa v183, 3, v183 dst_sel:DWORD dst_unused:UNUSED_PAD src0_sel:DWORD src1_sel:WORD_0
s_waitcnt lgkmcnt(8)
v_smfmac_f32_16x16x64_bf16 v[32:35], v[4:7], v[24:31], v1
ds_read_b64 v[24:25], v182
ds_read_b64 v[26:27], v2
ds_read_b64 v[28:29], v183
ds_read_b64 v[30:31], v3
s_waitcnt vmcnt(7)
v_mfma_f32_32x32x16_bf16 v[192:207], v[72:75], v[232:235], v[192:207]
s_add_u32 s30, s21, 40960
buffer_load_dwordx4 v[164:167], v0, s[4:7], s30 offen offset:128 sc1
s_waitcnt vmcnt(14)
v_lshlrev_b32_sdwa v2, 3, v184 dst_sel:DWORD dst_unused:UNUSED_PAD src0_sel:DWORD src1_sel:WORD_1
v_lshlrev_b32_sdwa v184, 3, v184 dst_sel:DWORD dst_unused:UNUSED_PAD src0_sel:DWORD src1_sel:WORD_0
v_lshlrev_b32_sdwa v3, 3, v185 dst_sel:DWORD dst_unused:UNUSED_PAD src0_sel:DWORD src1_sel:WORD_1
v_lshlrev_b32_sdwa v185, 3, v185 dst_sel:DWORD dst_unused:UNUSED_PAD src0_sel:DWORD src1_sel:WORD_0
s_waitcnt lgkmcnt(8)
v_smfmac_f32_16x16x64_bf16 v[32:35], v[4:7], v[8:15], v1
ds_read_b64 v[8:9], v184
ds_read_b64 v[10:11], v2
ds_read_b64 v[12:13], v185
ds_read_b64 v[14:15], v3
v_mfma_f32_32x32x16_bf16 v[208:223], v[72:75], v[248:251], v[208:223]
v_lshlrev_b32_sdwa v2, 3, v186 dst_sel:DWORD dst_unused:UNUSED_PAD src0_sel:DWORD src1_sel:WORD_1
v_lshlrev_b32_sdwa v186, 3, v186 dst_sel:DWORD dst_unused:UNUSED_PAD src0_sel:DWORD src1_sel:WORD_0
v_lshlrev_b32_sdwa v3, 3, v187 dst_sel:DWORD dst_unused:UNUSED_PAD src0_sel:DWORD src1_sel:WORD_1
v_lshlrev_b32_sdwa v187, 3, v187 dst_sel:DWORD dst_unused:UNUSED_PAD src0_sel:DWORD src1_sel:WORD_0
s_waitcnt lgkmcnt(8)
v_smfmac_f32_16x16x64_bf16 v[32:35], v[4:7], v[16:23], v1
ds_read_b64 v[16:17], v186
ds_read_b64 v[18:19], v2
ds_read_b64 v[20:21], v187
ds_read_b64 v[22:23], v3
s_waitcnt vmcnt(6)
v_mfma_f32_32x32x16_bf16 v[192:207], v[76:79], v[236:239], v[192:207]
s_add_u32 s30, s21, 40960
buffer_load_dwordx4 v[168:171], v0, s[4:7], s30 offen offset:256 sc1
v_lshlrev_b32_sdwa v2, 3, v188 dst_sel:DWORD dst_unused:UNUSED_PAD src0_sel:DWORD src1_sel:WORD_1
v_lshlrev_b32_sdwa v188, 3, v188 dst_sel:DWORD dst_unused:UNUSED_PAD src0_sel:DWORD src1_sel:WORD_0
v_lshlrev_b32_sdwa v3, 3, v189 dst_sel:DWORD dst_unused:UNUSED_PAD src0_sel:DWORD src1_sel:WORD_1
v_lshlrev_b32_sdwa v189, 3, v189 dst_sel:DWORD dst_unused:UNUSED_PAD src0_sel:DWORD src1_sel:WORD_0
s_waitcnt lgkmcnt(8)
v_smfmac_f32_16x16x64_bf16 v[32:35], v[4:7], v[24:31], v1
ds_read_b64 v[24:25], v188
ds_read_b64 v[26:27], v2
ds_read_b64 v[28:29], v189
ds_read_b64 v[30:31], v3
v_mfma_f32_32x32x16_bf16 v[208:223], v[76:79], v[252:255], v[208:223]
s_add_u32 s30, s21, 40960
buffer_load_dwordx4 v[172:175], v0, s[4:7], s30 offen offset:384 sc1
v_lshlrev_b32_sdwa v2, 3, v190 dst_sel:DWORD dst_unused:UNUSED_PAD src0_sel:DWORD src1_sel:WORD_1
v_lshlrev_b32_sdwa v190, 3, v190 dst_sel:DWORD dst_unused:UNUSED_PAD src0_sel:DWORD src1_sel:WORD_0
v_lshlrev_b32_sdwa v3, 3, v191 dst_sel:DWORD dst_unused:UNUSED_PAD src0_sel:DWORD src1_sel:WORD_1
v_lshlrev_b32_sdwa v191, 3, v191 dst_sel:DWORD dst_unused:UNUSED_PAD src0_sel:DWORD src1_sel:WORD_0
s_waitcnt lgkmcnt(8)
v_smfmac_f32_16x16x64_bf16 v[36:39], v[4:7], v[8:15], v1
ds_read_b64 v[8:9], v190
ds_read_b64 v[10:11], v2
ds_read_b64 v[12:13], v191
ds_read_b64 v[14:15], v3
s_add_u32 s30, s54, 0
buffer_load_dwordx4 v[64:67], v0, s[4:7], s30 offen offset:0 sc1
s_waitcnt vmcnt(7)
v_lshlrev_b32_sdwa v2, 3, v144 dst_sel:DWORD dst_unused:UNUSED_PAD src0_sel:DWORD src1_sel:WORD_1
v_lshlrev_b32_sdwa v144, 3, v144 dst_sel:DWORD dst_unused:UNUSED_PAD src0_sel:DWORD src1_sel:WORD_0
v_lshlrev_b32_sdwa v3, 3, v145 dst_sel:DWORD dst_unused:UNUSED_PAD src0_sel:DWORD src1_sel:WORD_1
v_lshlrev_b32_sdwa v145, 3, v145 dst_sel:DWORD dst_unused:UNUSED_PAD src0_sel:DWORD src1_sel:WORD_0
v_cvt_pk_bf16_f32 v176, v192, v208
v_cvt_pk_bf16_f32 v177, v193, v209
v_cvt_pk_bf16_f32 v178, v194, v210
v_cvt_pk_bf16_f32 v179, v195, v211
v_cvt_pk_bf16_f32 v180, v196, v212
v_cvt_pk_bf16_f32 v181, v197, v213
v_cvt_pk_bf16_f32 v182, v198, v214
v_cvt_pk_bf16_f32 v183, v199, v215
v_cvt_pk_bf16_f32 v184, v200, v216
v_cvt_pk_bf16_f32 v185, v201, v217
v_cvt_pk_bf16_f32 v186, v202, v218
v_cvt_pk_bf16_f32 v187, v203, v219
v_cvt_pk_bf16_f32 v188, v204, v220
v_cvt_pk_bf16_f32 v189, v205, v221
v_cvt_pk_bf16_f32 v190, v206, v222
v_cvt_pk_bf16_f32 v191, v207, v223
s_waitcnt lgkmcnt(8)
v_smfmac_f32_16x16x64_bf16 v[36:39], v[4:7], v[16:23], v1
ds_read_b64 v[16:17], v144
ds_read_b64 v[18:19], v2
ds_read_b64 v[20:21], v145
ds_read_b64 v[22:23], v3
v_mfma_f32_32x32x16_bf16 v[192:207], v[80:83], v[224:227], 0
s_add_u32 s30, s54, 0
buffer_load_dwordx4 v[68:71], v0, s[4:7], s30 offen offset:128 sc1
v_lshlrev_b32_sdwa v2, 3, v146 dst_sel:DWORD dst_unused:UNUSED_PAD src0_sel:DWORD src1_sel:WORD_1
v_lshlrev_b32_sdwa v146, 3, v146 dst_sel:DWORD dst_unused:UNUSED_PAD src0_sel:DWORD src1_sel:WORD_0
v_lshlrev_b32_sdwa v3, 3, v147 dst_sel:DWORD dst_unused:UNUSED_PAD src0_sel:DWORD src1_sel:WORD_1
v_lshlrev_b32_sdwa v147, 3, v147 dst_sel:DWORD dst_unused:UNUSED_PAD src0_sel:DWORD src1_sel:WORD_0
s_waitcnt lgkmcnt(8)
v_smfmac_f32_16x16x64_bf16 v[36:39], v[4:7], v[24:31], v1
ds_read_b64 v[24:25], v146
ds_read_b64 v[26:27], v2
ds_read_b64 v[28:29], v147
ds_read_b64 v[30:31], v3
v_mfma_f32_32x32x16_bf16 v[208:223], v[80:83], v[240:243], 0
v_mfma_f32_32x32x16_bf16 v[192:207], v[84:87], v[228:231], v[192:207]
s_add_u32 s30, s54, 0
buffer_load_dwordx4 v[72:75], v0, s[4:7], s30 offen offset:256 sc1
v_lshlrev_b32_sdwa v2, 3, v148 dst_sel:DWORD dst_unused:UNUSED_PAD src0_sel:DWORD src1_sel:WORD_1
v_lshlrev_b32_sdwa v148, 3, v148 dst_sel:DWORD dst_unused:UNUSED_PAD src0_sel:DWORD src1_sel:WORD_0
v_lshlrev_b32_sdwa v3, 3, v149 dst_sel:DWORD dst_unused:UNUSED_PAD src0_sel:DWORD src1_sel:WORD_1
v_lshlrev_b32_sdwa v149, 3, v149 dst_sel:DWORD dst_unused:UNUSED_PAD src0_sel:DWORD src1_sel:WORD_0
s_waitcnt lgkmcnt(8)
v_smfmac_f32_16x16x64_bf16 v[36:39], v[4:7], v[8:15], v1
ds_read_b64 v[8:9], v148
ds_read_b64 v[10:11], v2
ds_read_b64 v[12:13], v149
ds_read_b64 v[14:15], v3
v_mfma_f32_32x32x16_bf16 v[208:223], v[84:87], v[244:247], v[208:223]
s_add_u32 s30, s54, 0
buffer_load_dwordx4 v[76:79], v0, s[4:7], s30 offen offset:384 sc1
v_lshlrev_b32_sdwa v2, 3, v150 dst_sel:DWORD dst_unused:UNUSED_PAD src0_sel:DWORD src1_sel:WORD_1
v_lshlrev_b32_sdwa v150, 3, v150 dst_sel:DWORD dst_unused:UNUSED_PAD src0_sel:DWORD src1_sel:WORD_0
v_lshlrev_b32_sdwa v3, 3, v151 dst_sel:DWORD dst_unused:UNUSED_PAD src0_sel:DWORD src1_sel:WORD_1
v_lshlrev_b32_sdwa v151, 3, v151 dst_sel:DWORD dst_unused:UNUSED_PAD src0_sel:DWORD src1_sel:WORD_0
s_waitcnt lgkmcnt(8)
v_smfmac_f32_16x16x64_bf16 v[40:43], v[4:7], v[16:23], v1
ds_read_b64 v[16:17], v150
ds_read_b64 v[18:19], v2
ds_read_b64 v[20:21], v151
ds_read_b64 v[22:23], v3
v_mfma_f32_32x32x16_bf16 v[192:207], v[88:91], v[232:235], v[192:207]
s_add_u32 s30, s21, 40960
buffer_load_dwordx4 v[128:131], v0, s[4:7], s30 offen offset:512 sc1
s_waitcnt vmcnt(9)
v_lshlrev_b32_sdwa v2, 3, v152 dst_sel:DWORD dst_unused:UNUSED_PAD src0_sel:DWORD src1_sel:WORD_1
v_lshlrev_b32_sdwa v152, 3, v152 dst_sel:DWORD dst_unused:UNUSED_PAD src0_sel:DWORD src1_sel:WORD_0
v_lshlrev_b32_sdwa v3, 3, v153 dst_sel:DWORD dst_unused:UNUSED_PAD src0_sel:DWORD src1_sel:WORD_1
v_lshlrev_b32_sdwa v153, 3, v153 dst_sel:DWORD dst_unused:UNUSED_PAD src0_sel:DWORD src1_sel:WORD_0
s_waitcnt lgkmcnt(8)
v_smfmac_f32_16x16x64_bf16 v[40:43], v[4:7], v[24:31], v1
ds_read_b64 v[24:25], v152
ds_read_b64 v[26:27], v2
ds_read_b64 v[28:29], v153
ds_read_b64 v[30:31], v3
v_mfma_f32_32x32x16_bf16 v[208:223], v[88:91], v[248:251], v[208:223]
s_add_u32 s30, s21, 40960
buffer_load_dwordx4 v[132:135], v0, s[4:7], s30 offen offset:640 sc1
v_lshlrev_b32_sdwa v2, 3, v154 dst_sel:DWORD dst_unused:UNUSED_PAD src0_sel:DWORD src1_sel:WORD_1
v_lshlrev_b32_sdwa v154, 3, v154 dst_sel:DWORD dst_unused:UNUSED_PAD src0_sel:DWORD src1_sel:WORD_0
v_lshlrev_b32_sdwa v3, 3, v155 dst_sel:DWORD dst_unused:UNUSED_PAD src0_sel:DWORD src1_sel:WORD_1
v_lshlrev_b32_sdwa v155, 3, v155 dst_sel:DWORD dst_unused:UNUSED_PAD src0_sel:DWORD src1_sel:WORD_0
s_waitcnt lgkmcnt(8)
v_smfmac_f32_16x16x64_bf16 v[40:43], v[4:7], v[8:15], v1
ds_read_b64 v[8:9], v154
ds_read_b64 v[10:11], v2
ds_read_b64 v[12:13], v155
ds_read_b64 v[14:15], v3
v_mfma_f32_32x32x16_bf16 v[192:207], v[92:95], v[236:239], v[192:207]
s_add_u32 s30, s21, 40960
buffer_load_dwordx4 v[136:139], v0, s[4:7], s30 offen offset:768 sc1
v_lshlrev_b32_sdwa v2, 3, v156 dst_sel:DWORD dst_unused:UNUSED_PAD src0_sel:DWORD src1_sel:WORD_1
v_lshlrev_b32_sdwa v156, 3, v156 dst_sel:DWORD dst_unused:UNUSED_PAD src0_sel:DWORD src1_sel:WORD_0
v_lshlrev_b32_sdwa v3, 3, v157 dst_sel:DWORD dst_unused:UNUSED_PAD src0_sel:DWORD src1_sel:WORD_1
v_lshlrev_b32_sdwa v157, 3, v157 dst_sel:DWORD dst_unused:UNUSED_PAD src0_sel:DWORD src1_sel:WORD_0
s_waitcnt lgkmcnt(8)
v_smfmac_f32_16x16x64_bf16 v[40:43], v[4:7], v[16:23], v1
ds_read_b64 v[16:17], v156
ds_read_b64 v[18:19], v2
ds_read_b64 v[20:21], v157
ds_read_b64 v[22:23], v3
v_mfma_f32_32x32x16_bf16 v[208:223], v[92:95], v[252:255], v[208:223]
s_add_u32 s30, s21, 40960
buffer_load_dwordx4 v[140:143], v0, s[4:7], s30 offen offset:896 sc1
v_lshlrev_b32_sdwa v2, 3, v158 dst_sel:DWORD dst_unused:UNUSED_PAD src0_sel:DWORD src1_sel:WORD_1
v_lshlrev_b32_sdwa v158, 3, v158 dst_sel:DWORD dst_unused:UNUSED_PAD src0_sel:DWORD src1_sel:WORD_0
v_lshlrev_b32_sdwa v3, 3, v159 dst_sel:DWORD dst_unused:UNUSED_PAD src0_sel:DWORD src1_sel:WORD_1
v_lshlrev_b32_sdwa v159, 3, v159 dst_sel:DWORD dst_unused:UNUSED_PAD src0_sel:DWORD src1_sel:WORD_0
s_waitcnt lgkmcnt(8)
v_smfmac_f32_16x16x64_bf16 v[44:47], v[4:7], v[24:31], v1
ds_read_b64 v[24:25], v158
ds_read_b64 v[26:27], v2
ds_read_b64 v[28:29], v159
ds_read_b64 v[30:31], v3
s_add_u32 s30, s54, 0
buffer_load_dwordx4 v[80:83], v0, s[4:7], s30 offen offset:512 sc1
s_waitcnt vmcnt(11)
v_lshlrev_b32_sdwa v2, 3, v160 dst_sel:DWORD dst_unused:UNUSED_PAD src0_sel:DWORD src1_sel:WORD_1
v_lshlrev_b32_sdwa v160, 3, v160 dst_sel:DWORD dst_unused:UNUSED_PAD src0_sel:DWORD src1_sel:WORD_0
v_lshlrev_b32_sdwa v3, 3, v161 dst_sel:DWORD dst_unused:UNUSED_PAD src0_sel:DWORD src1_sel:WORD_1
v_lshlrev_b32_sdwa v161, 3, v161 dst_sel:DWORD dst_unused:UNUSED_PAD src0_sel:DWORD src1_sel:WORD_0
v_cvt_pk_bf16_f32 v144, v192, v208
v_cvt_pk_bf16_f32 v145, v193, v209
v_cvt_pk_bf16_f32 v146, v194, v210
v_cvt_pk_bf16_f32 v147, v195, v211
v_cvt_pk_bf16_f32 v148, v196, v212
v_cvt_pk_bf16_f32 v149, v197, v213
v_cvt_pk_bf16_f32 v150, v198, v214
v_cvt_pk_bf16_f32 v151, v199, v215
v_cvt_pk_bf16_f32 v152, v200, v216
v_cvt_pk_bf16_f32 v153, v201, v217
v_cvt_pk_bf16_f32 v154, v202, v218
v_cvt_pk_bf16_f32 v155, v203, v219
v_cvt_pk_bf16_f32 v156, v204, v220
v_cvt_pk_bf16_f32 v157, v205, v221
v_cvt_pk_bf16_f32 v158, v206, v222
v_cvt_pk_bf16_f32 v159, v207, v223
s_waitcnt lgkmcnt(8)
v_smfmac_f32_16x16x64_bf16 v[44:47], v[4:7], v[8:15], v1
ds_read_b64 v[8:9], v160
ds_read_b64 v[10:11], v2
ds_read_b64 v[12:13], v161
ds_read_b64 v[14:15], v3
s_waitcnt vmcnt(5)
v_mfma_f32_32x32x16_bf16 v[192:207], v[64:67], v[224:227], 0
s_add_u32 s30, s54, 0
buffer_load_dwordx4 v[84:87], v0, s[4:7], s30 offen offset:640 sc1
v_lshlrev_b32_sdwa v2, 3, v162 dst_sel:DWORD dst_unused:UNUSED_PAD src0_sel:DWORD src1_sel:WORD_1
v_lshlrev_b32_sdwa v162, 3, v162 dst_sel:DWORD dst_unused:UNUSED_PAD src0_sel:DWORD src1_sel:WORD_0
v_lshlrev_b32_sdwa v3, 3, v163 dst_sel:DWORD dst_unused:UNUSED_PAD src0_sel:DWORD src1_sel:WORD_1
v_lshlrev_b32_sdwa v163, 3, v163 dst_sel:DWORD dst_unused:UNUSED_PAD src0_sel:DWORD src1_sel:WORD_0
s_waitcnt lgkmcnt(8)
v_smfmac_f32_16x16x64_bf16 v[44:47], v[4:7], v[16:23], v1
ds_read_b64 v[16:17], v162
ds_read_b64 v[18:19], v2
ds_read_b64 v[20:21], v163
ds_read_b64 v[22:23], v3
v_mfma_f32_32x32x16_bf16 v[208:223], v[64:67], v[240:243], 0
v_mfma_f32_32x32x16_bf16 v[192:207], v[68:71], v[228:231], v[192:207]
s_add_u32 s30, s54, 0
buffer_load_dwordx4 v[88:91], v0, s[4:7], s30 offen offset:768 sc1
v_lshlrev_b32_sdwa v2, 3, v164 dst_sel:DWORD dst_unused:UNUSED_PAD src0_sel:DWORD src1_sel:WORD_1
v_lshlrev_b32_sdwa v164, 3, v164 dst_sel:DWORD dst_unused:UNUSED_PAD src0_sel:DWORD src1_sel:WORD_0
v_lshlrev_b32_sdwa v3, 3, v165 dst_sel:DWORD dst_unused:UNUSED_PAD src0_sel:DWORD src1_sel:WORD_1
v_lshlrev_b32_sdwa v165, 3, v165 dst_sel:DWORD dst_unused:UNUSED_PAD src0_sel:DWORD src1_sel:WORD_0
s_waitcnt lgkmcnt(8)
v_smfmac_f32_16x16x64_bf16 v[44:47], v[4:7], v[24:31], v1
ds_read_b64 v[24:25], v164
ds_read_b64 v[26:27], v2
ds_read_b64 v[28:29], v165
ds_read_b64 v[30:31], v3
v_mfma_f32_32x32x16_bf16 v[208:223], v[68:71], v[244:247], v[208:223]
s_add_u32 s30, s54, 0
buffer_load_dwordx4 v[92:95], v0, s[4:7], s30 offen offset:896 sc1
v_lshlrev_b32_sdwa v2, 3, v166 dst_sel:DWORD dst_unused:UNUSED_PAD src0_sel:DWORD src1_sel:WORD_1
v_lshlrev_b32_sdwa v166, 3, v166 dst_sel:DWORD dst_unused:UNUSED_PAD src0_sel:DWORD src1_sel:WORD_0
v_lshlrev_b32_sdwa v3, 3, v167 dst_sel:DWORD dst_unused:UNUSED_PAD src0_sel:DWORD src1_sel:WORD_1
v_lshlrev_b32_sdwa v167, 3, v167 dst_sel:DWORD dst_unused:UNUSED_PAD src0_sel:DWORD src1_sel:WORD_0
s_waitcnt lgkmcnt(8)
v_smfmac_f32_16x16x64_bf16 v[48:51], v[4:7], v[8:15], v1
ds_read_b64 v[8:9], v166
ds_read_b64 v[10:11], v2
ds_read_b64 v[12:13], v167
ds_read_b64 v[14:15], v3
v_mfma_f32_32x32x16_bf16 v[192:207], v[72:75], v[232:235], v[192:207]
s_waitcnt vmcnt(12)
v_lshlrev_b32_sdwa v2, 3, v168 dst_sel:DWORD dst_unused:UNUSED_PAD src0_sel:DWORD src1_sel:WORD_1
v_lshlrev_b32_sdwa v168, 3, v168 dst_sel:DWORD dst_unused:UNUSED_PAD src0_sel:DWORD src1_sel:WORD_0
v_lshlrev_b32_sdwa v3, 3, v169 dst_sel:DWORD dst_unused:UNUSED_PAD src0_sel:DWORD src1_sel:WORD_1
v_lshlrev_b32_sdwa v169, 3, v169 dst_sel:DWORD dst_unused:UNUSED_PAD src0_sel:DWORD src1_sel:WORD_0
s_waitcnt lgkmcnt(8)
v_smfmac_f32_16x16x64_bf16 v[48:51], v[4:7], v[16:23], v1
ds_read_b64 v[16:17], v168
ds_read_b64 v[18:19], v2
ds_read_b64 v[20:21], v169
ds_read_b64 v[22:23], v3
v_mfma_f32_32x32x16_bf16 v[208:223], v[72:75], v[248:251], v[208:223]
v_lshlrev_b32_sdwa v2, 3, v170 dst_sel:DWORD dst_unused:UNUSED_PAD src0_sel:DWORD src1_sel:WORD_1
v_lshlrev_b32_sdwa v170, 3, v170 dst_sel:DWORD dst_unused:UNUSED_PAD src0_sel:DWORD src1_sel:WORD_0
v_lshlrev_b32_sdwa v3, 3, v171 dst_sel:DWORD dst_unused:UNUSED_PAD src0_sel:DWORD src1_sel:WORD_1
v_lshlrev_b32_sdwa v171, 3, v171 dst_sel:DWORD dst_unused:UNUSED_PAD src0_sel:DWORD src1_sel:WORD_0
s_waitcnt lgkmcnt(8)
v_smfmac_f32_16x16x64_bf16 v[48:51], v[4:7], v[24:31], v1
ds_read_b64 v[24:25], v170
ds_read_b64 v[26:27], v2
ds_read_b64 v[28:29], v171
ds_read_b64 v[30:31], v3
v_mfma_f32_32x32x16_bf16 v[192:207], v[76:79], v[236:239], v[192:207]
v_lshlrev_b32_sdwa v2, 3, v172 dst_sel:DWORD dst_unused:UNUSED_PAD src0_sel:DWORD src1_sel:WORD_1
v_lshlrev_b32_sdwa v172, 3, v172 dst_sel:DWORD dst_unused:UNUSED_PAD src0_sel:DWORD src1_sel:WORD_0
v_lshlrev_b32_sdwa v3, 3, v173 dst_sel:DWORD dst_unused:UNUSED_PAD src0_sel:DWORD src1_sel:WORD_1
v_lshlrev_b32_sdwa v173, 3, v173 dst_sel:DWORD dst_unused:UNUSED_PAD src0_sel:DWORD src1_sel:WORD_0
s_waitcnt lgkmcnt(8)
v_smfmac_f32_16x16x64_bf16 v[48:51], v[4:7], v[8:15], v1
ds_read_b64 v[8:9], v172
ds_read_b64 v[10:11], v2
ds_read_b64 v[12:13], v173
ds_read_b64 v[14:15], v3
v_mfma_f32_32x32x16_bf16 v[208:223], v[76:79], v[252:255], v[208:223]
v_lshlrev_b32_sdwa v2, 3, v174 dst_sel:DWORD dst_unused:UNUSED_PAD src0_sel:DWORD src1_sel:WORD_1
v_lshlrev_b32_sdwa v174, 3, v174 dst_sel:DWORD dst_unused:UNUSED_PAD src0_sel:DWORD src1_sel:WORD_0
v_lshlrev_b32_sdwa v3, 3, v175 dst_sel:DWORD dst_unused:UNUSED_PAD src0_sel:DWORD src1_sel:WORD_1
v_lshlrev_b32_sdwa v175, 3, v175 dst_sel:DWORD dst_unused:UNUSED_PAD src0_sel:DWORD src1_sel:WORD_0
s_waitcnt lgkmcnt(8)
v_smfmac_f32_16x16x64_bf16 v[52:55], v[4:7], v[16:23], v1
ds_read_b64 v[16:17], v174
ds_read_b64 v[18:19], v2
ds_read_b64 v[20:21], v175
ds_read_b64 v[22:23], v3
s_waitcnt vmcnt(6)
v_lshlrev_b32_sdwa v2, 3, v128 dst_sel:DWORD dst_unused:UNUSED_PAD src0_sel:DWORD src1_sel:WORD_1
v_lshlrev_b32_sdwa v128, 3, v128 dst_sel:DWORD dst_unused:UNUSED_PAD src0_sel:DWORD src1_sel:WORD_0
v_lshlrev_b32_sdwa v3, 3, v129 dst_sel:DWORD dst_unused:UNUSED_PAD src0_sel:DWORD src1_sel:WORD_1
v_lshlrev_b32_sdwa v129, 3, v129 dst_sel:DWORD dst_unused:UNUSED_PAD src0_sel:DWORD src1_sel:WORD_0
v_cvt_pk_bf16_f32 v160, v192, v208
v_cvt_pk_bf16_f32 v161, v193, v209
v_cvt_pk_bf16_f32 v162, v194, v210
v_cvt_pk_bf16_f32 v163, v195, v211
v_cvt_pk_bf16_f32 v164, v196, v212
v_cvt_pk_bf16_f32 v165, v197, v213
v_cvt_pk_bf16_f32 v166, v198, v214
v_cvt_pk_bf16_f32 v167, v199, v215
v_cvt_pk_bf16_f32 v168, v200, v216
v_cvt_pk_bf16_f32 v169, v201, v217
v_cvt_pk_bf16_f32 v170, v202, v218
v_cvt_pk_bf16_f32 v171, v203, v219
v_cvt_pk_bf16_f32 v172, v204, v220
v_cvt_pk_bf16_f32 v173, v205, v221
v_cvt_pk_bf16_f32 v174, v206, v222
v_cvt_pk_bf16_f32 v175, v207, v223
s_waitcnt lgkmcnt(8)
v_smfmac_f32_16x16x64_bf16 v[52:55], v[4:7], v[24:31], v1
ds_read_b64 v[24:25], v128
ds_read_b64 v[26:27], v2
ds_read_b64 v[28:29], v129
ds_read_b64 v[30:31], v3
s_waitcnt vmcnt(0)
v_mfma_f32_32x32x16_bf16 v[192:207], v[80:83], v[224:227], 0
v_lshlrev_b32_sdwa v2, 3, v130 dst_sel:DWORD dst_unused:UNUSED_PAD src0_sel:DWORD src1_sel:WORD_1
v_lshlrev_b32_sdwa v130, 3, v130 dst_sel:DWORD dst_unused:UNUSED_PAD src0_sel:DWORD src1_sel:WORD_0
v_lshlrev_b32_sdwa v3, 3, v131 dst_sel:DWORD dst_unused:UNUSED_PAD src0_sel:DWORD src1_sel:WORD_1
v_lshlrev_b32_sdwa v131, 3, v131 dst_sel:DWORD dst_unused:UNUSED_PAD src0_sel:DWORD src1_sel:WORD_0
s_waitcnt lgkmcnt(8)
v_smfmac_f32_16x16x64_bf16 v[52:55], v[4:7], v[8:15], v1
ds_read_b64 v[8:9], v130
ds_read_b64 v[10:11], v2
ds_read_b64 v[12:13], v131
ds_read_b64 v[14:15], v3
v_mfma_f32_32x32x16_bf16 v[208:223], v[80:83], v[240:243], 0
v_mfma_f32_32x32x16_bf16 v[192:207], v[84:87], v[228:231], v[192:207]
s_add_u32 s30, s20, 65536
buffer_load_dwordx4 v[128:131], v0, s[4:7], s30 offen offset:0 sc1
v_lshlrev_b32_sdwa v2, 3, v132 dst_sel:DWORD dst_unused:UNUSED_PAD src0_sel:DWORD src1_sel:WORD_1
v_lshlrev_b32_sdwa v132, 3, v132 dst_sel:DWORD dst_unused:UNUSED_PAD src0_sel:DWORD src1_sel:WORD_0
v_lshlrev_b32_sdwa v3, 3, v133 dst_sel:DWORD dst_unused:UNUSED_PAD src0_sel:DWORD src1_sel:WORD_1
v_lshlrev_b32_sdwa v133, 3, v133 dst_sel:DWORD dst_unused:UNUSED_PAD src0_sel:DWORD src1_sel:WORD_0
s_waitcnt lgkmcnt(8)
v_smfmac_f32_16x16x64_bf16 v[52:55], v[4:7], v[16:23], v1
ds_read_b64 v[16:17], v132
ds_read_b64 v[18:19], v2
ds_read_b64 v[20:21], v133
ds_read_b64 v[22:23], v3
v_mfma_f32_32x32x16_bf16 v[208:223], v[84:87], v[244:247], v[208:223]
v_lshlrev_b32_sdwa v2, 3, v134 dst_sel:DWORD dst_unused:UNUSED_PAD src0_sel:DWORD src1_sel:WORD_1
v_lshlrev_b32_sdwa v134, 3, v134 dst_sel:DWORD dst_unused:UNUSED_PAD src0_sel:DWORD src1_sel:WORD_0
v_lshlrev_b32_sdwa v3, 3, v135 dst_sel:DWORD dst_unused:UNUSED_PAD src0_sel:DWORD src1_sel:WORD_1
v_lshlrev_b32_sdwa v135, 3, v135 dst_sel:DWORD dst_unused:UNUSED_PAD src0_sel:DWORD src1_sel:WORD_0
s_waitcnt lgkmcnt(8)
v_smfmac_f32_16x16x64_bf16 v[56:59], v[4:7], v[24:31], v1
ds_read_b64 v[24:25], v134
ds_read_b64 v[26:27], v2
ds_read_b64 v[28:29], v135
ds_read_b64 v[30:31], v3
v_mfma_f32_32x32x16_bf16 v[192:207], v[88:91], v[232:235], v[192:207]
s_add_u32 s30, s20, 65536
buffer_load_dwordx4 v[132:135], v0, s[4:7], s30 offen offset:128 sc1
s_waitcnt vmcnt(6)
v_lshlrev_b32_sdwa v2, 3, v136 dst_sel:DWORD dst_unused:UNUSED_PAD src0_sel:DWORD src1_sel:WORD_1
v_lshlrev_b32_sdwa v136, 3, v136 dst_sel:DWORD dst_unused:UNUSED_PAD src0_sel:DWORD src1_sel:WORD_0
v_lshlrev_b32_sdwa v3, 3, v137 dst_sel:DWORD dst_unused:UNUSED_PAD src0_sel:DWORD src1_sel:WORD_1
v_lshlrev_b32_sdwa v137, 3, v137 dst_sel:DWORD dst_unused:UNUSED_PAD src0_sel:DWORD src1_sel:WORD_0
s_waitcnt lgkmcnt(8)
v_smfmac_f32_16x16x64_bf16 v[56:59], v[4:7], v[8:15], v1
ds_read_b64 v[8:9], v136
ds_read_b64 v[10:11], v2
ds_read_b64 v[12:13], v137
ds_read_b64 v[14:15], v3
v_mfma_f32_32x32x16_bf16 v[208:223], v[88:91], v[248:251], v[208:223]
v_lshlrev_b32_sdwa v2, 3, v138 dst_sel:DWORD dst_unused:UNUSED_PAD src0_sel:DWORD src1_sel:WORD_1
v_lshlrev_b32_sdwa v138, 3, v138 dst_sel:DWORD dst_unused:UNUSED_PAD src0_sel:DWORD src1_sel:WORD_0
v_lshlrev_b32_sdwa v3, 3, v139 dst_sel:DWORD dst_unused:UNUSED_PAD src0_sel:DWORD src1_sel:WORD_1
v_lshlrev_b32_sdwa v139, 3, v139 dst_sel:DWORD dst_unused:UNUSED_PAD src0_sel:DWORD src1_sel:WORD_0
s_waitcnt lgkmcnt(8)
v_smfmac_f32_16x16x64_bf16 v[56:59], v[4:7], v[16:23], v1
ds_read_b64 v[16:17], v138
ds_read_b64 v[18:19], v2
ds_read_b64 v[20:21], v139
ds_read_b64 v[22:23], v3
v_mfma_f32_32x32x16_bf16 v[192:207], v[92:95], v[236:239], v[192:207]
s_add_u32 s30, s20, 65536
buffer_load_dwordx4 v[136:139], v0, s[4:7], s30 offen offset:256 sc1
v_lshlrev_b32_sdwa v2, 3, v140 dst_sel:DWORD dst_unused:UNUSED_PAD src0_sel:DWORD src1_sel:WORD_1
v_lshlrev_b32_sdwa v140, 3, v140 dst_sel:DWORD dst_unused:UNUSED_PAD src0_sel:DWORD src1_sel:WORD_0
v_lshlrev_b32_sdwa v3, 3, v141 dst_sel:DWORD dst_unused:UNUSED_PAD src0_sel:DWORD src1_sel:WORD_1
v_lshlrev_b32_sdwa v141, 3, v141 dst_sel:DWORD dst_unused:UNUSED_PAD src0_sel:DWORD src1_sel:WORD_0
s_waitcnt lgkmcnt(8)
v_smfmac_f32_16x16x64_bf16 v[56:59], v[4:7], v[24:31], v1
ds_read_b64 v[24:25], v140
ds_read_b64 v[26:27], v2
ds_read_b64 v[28:29], v141
ds_read_b64 v[30:31], v3
v_mfma_f32_32x32x16_bf16 v[208:223], v[92:95], v[252:255], v[208:223]
v_lshlrev_b32_sdwa v2, 3, v142 dst_sel:DWORD dst_unused:UNUSED_PAD src0_sel:DWORD src1_sel:WORD_1
v_lshlrev_b32_sdwa v142, 3, v142 dst_sel:DWORD dst_unused:UNUSED_PAD src0_sel:DWORD src1_sel:WORD_0
v_lshlrev_b32_sdwa v3, 3, v143 dst_sel:DWORD dst_unused:UNUSED_PAD src0_sel:DWORD src1_sel:WORD_1
v_lshlrev_b32_sdwa v143, 3, v143 dst_sel:DWORD dst_unused:UNUSED_PAD src0_sel:DWORD src1_sel:WORD_0
s_waitcnt lgkmcnt(8)
v_smfmac_f32_16x16x64_bf16 v[60:63], v[4:7], v[8:15], v1
ds_read_b64 v[8:9], v142
ds_read_b64 v[10:11], v2
ds_read_b64 v[12:13], v143
ds_read_b64 v[14:15], v3
s_add_u32 s30, s20, 65536
buffer_load_dwordx4 v[140:143], v0, s[4:7], s30 offen offset:384 sc1
s_waitcnt lgkmcnt(8)
v_smfmac_f32_16x16x64_bf16 v[60:63], v[4:7], v[16:23], v1
s_waitcnt lgkmcnt(4)
v_smfmac_f32_16x16x64_bf16 v[60:63], v[4:7], v[24:31], v1
v_cvt_pk_bf16_f32 v192, v192, v208
v_cvt_pk_bf16_f32 v193, v193, v209
v_cvt_pk_bf16_f32 v194, v194, v210
v_cvt_pk_bf16_f32 v195, v195, v211
v_cvt_pk_bf16_f32 v196, v196, v212
v_cvt_pk_bf16_f32 v197, v197, v213
v_cvt_pk_bf16_f32 v198, v198, v214
v_cvt_pk_bf16_f32 v199, v199, v215
v_cvt_pk_bf16_f32 v200, v200, v216
v_cvt_pk_bf16_f32 v201, v201, v217
v_cvt_pk_bf16_f32 v202, v202, v218
v_cvt_pk_bf16_f32 v203, v203, v219
v_cvt_pk_bf16_f32 v204, v204, v220
v_cvt_pk_bf16_f32 v205, v205, v221
v_cvt_pk_bf16_f32 v206, v206, v222
v_cvt_pk_bf16_f32 v207, v207, v223
s_waitcnt lgkmcnt(0)
s_barrier
s_mov_b32 m0, s24
s_nop 0
ds_write_addtid_b32 v144 offset:61568
ds_write_addtid_b32 v145 offset:61824
ds_write_addtid_b32 v146 offset:62080
ds_write_addtid_b32 v147 offset:62336
ds_write_addtid_b32 v148 offset:62592
ds_write_addtid_b32 v149 offset:62848
ds_write_addtid_b32 v150 offset:63104
ds_write_addtid_b32 v151 offset:63360
ds_write_addtid_b32 v152 offset:63616
v_smfmac_f32_16x16x64_bf16 v[60:63], v[4:7], v[8:15], v1
ds_write_addtid_b32 v153 offset:63872
ds_write_addtid_b32 v154 offset:64128
ds_write_addtid_b32 v155 offset:64384
ds_write_addtid_b32 v156 offset:64640
ds_write_addtid_b32 v157 offset:64896
ds_write_addtid_b32 v158 offset:65152
ds_write_addtid_b32 v159 offset:65408
ds_write_addtid_b32 v176 offset:28800
ds_write_addtid_b32 v177 offset:29056
ds_write_addtid_b32 v178 offset:29312
ds_write_addtid_b32 v179 offset:29568
ds_write_addtid_b32 v180 offset:29824
ds_write_addtid_b32 v181 offset:30080
ds_write_addtid_b32 v182 offset:30336
ds_write_addtid_b32 v183 offset:30592
ds_write_addtid_b32 v184 offset:30848
ds_write_addtid_b32 v185 offset:31104
ds_write_addtid_b32 v186 offset:31360
ds_write_addtid_b32 v187 offset:31616
ds_write_addtid_b32 v188 offset:31872
ds_write_addtid_b32 v189 offset:32128
ds_write_addtid_b32 v190 offset:32384
ds_write_addtid_b32 v191 offset:32640
s_mov_b32 m0, s23
s_nop 0
s_add_u32 s30, s20, 65536
buffer_load_dwordx4 v[144:147], v0, s[4:7], s30 offen offset:512 sc1
ds_write_addtid_b32 v160 offset:0
ds_write_addtid_b32 v161 offset:256
ds_write_addtid_b32 v162 offset:512
ds_write_addtid_b32 v163 offset:768
ds_write_addtid_b32 v164 offset:1024
ds_write_addtid_b32 v165 offset:1280
ds_write_addtid_b32 v166 offset:1536
ds_write_addtid_b32 v167 offset:1792
s_add_u32 s30, s20, 65536
buffer_load_dwordx4 v[148:151], v0, s[4:7], s30 offen offset:640 sc1
ds_write_addtid_b32 v168 offset:2048
ds_write_addtid_b32 v169 offset:2304
ds_write_addtid_b32 v170 offset:2560
ds_write_addtid_b32 v171 offset:2816
ds_write_addtid_b32 v172 offset:3072
ds_write_addtid_b32 v173 offset:3328
ds_write_addtid_b32 v174 offset:3584
ds_write_addtid_b32 v175 offset:3840
s_add_u32 s30, s20, 65536
buffer_load_dwordx4 v[152:155], v0, s[4:7], s30 offen offset:768 sc1
ds_write_addtid_b32 v192 offset:32768
ds_write_addtid_b32 v193 offset:33024
ds_write_addtid_b32 v194 offset:33280
ds_write_addtid_b32 v195 offset:33536
ds_write_addtid_b32 v196 offset:33792
ds_write_addtid_b32 v197 offset:34048
ds_write_addtid_b32 v198 offset:34304
ds_write_addtid_b32 v199 offset:34560
s_add_u32 s30, s20, 65536
buffer_load_dwordx4 v[156:159], v0, s[4:7], s30 offen offset:896 sc1
ds_write_addtid_b32 v200 offset:34816
ds_write_addtid_b32 v201 offset:35072
ds_write_addtid_b32 v202 offset:35328
ds_write_addtid_b32 v203 offset:35584
ds_write_addtid_b32 v204 offset:35840
ds_write_addtid_b32 v205 offset:36096
ds_write_addtid_b32 v206 offset:36352
ds_write_addtid_b32 v207 offset:36608
s_waitcnt vmcnt(6)
v_lshlrev_b32_sdwa v2, 3, v128 dst_sel:DWORD dst_unused:UNUSED_PAD src0_sel:DWORD src1_sel:WORD_1
v_lshlrev_b32_sdwa v128, 3, v128 dst_sel:DWORD dst_unused:UNUSED_PAD src0_sel:DWORD src1_sel:WORD_0
v_lshlrev_b32_sdwa v3, 3, v129 dst_sel:DWORD dst_unused:UNUSED_PAD src0_sel:DWORD src1_sel:WORD_1
v_lshlrev_b32_sdwa v129, 3, v129 dst_sel:DWORD dst_unused:UNUSED_PAD src0_sel:DWORD src1_sel:WORD_0
s_waitcnt lgkmcnt(0)
s_barrier
ds_read_b64 v[8:9], v128
ds_read_b64 v[10:11], v2
ds_read_b64 v[12:13], v129
ds_read_b64 v[14:15], v3
s_xor_b32 s55, s28, 64
s_lshl_b32 s55, s55, 3
s_add_u32 s55, s55, s3
s_lshl_b32 s55, s55, 13
s_add_u32 s55, s55, 0x1000000
s_xor_b32 s24, s55, 0x400000
s_add_u32 s30, s20, 73728
buffer_load_dwordx4 v[160:163], v0, s[4:7], s30 offen offset:0 sc1
v_lshlrev_b32_sdwa v2, 3, v130 dst_sel:DWORD dst_unused:UNUSED_PAD src0_sel:DWORD src1_sel:WORD_1
v_lshlrev_b32_sdwa v130, 3, v130 dst_sel:DWORD dst_unused:UNUSED_PAD src0_sel:DWORD src1_sel:WORD_0
v_lshlrev_b32_sdwa v3, 3, v131 dst_sel:DWORD dst_unused:UNUSED_PAD src0_sel:DWORD src1_sel:WORD_1
v_lshlrev_b32_sdwa v131, 3, v131 dst_sel:DWORD dst_unused:UNUSED_PAD src0_sel:DWORD src1_sel:WORD_0
ds_read_b64 v[16:17], v130
ds_read_b64 v[18:19], v2
ds_read_b64 v[20:21], v131
ds_read_b64 v[22:23], v3
v_mbcnt_lo_u32_b32 v241, -1, 0
v_mbcnt_hi_u32_b32 v241, -1, v241
v_and_b32 v240, 0x7f, v0
v_and_b32 v242, 4, v241
v_lshl_or_b32 v240, v242, 8, v240
v_and_b32 v242, 8, v241
v_lshl_or_b32 v240, v242, 6, v240
v_and_b32 v242, 16, v241
v_lshl_or_b32 v240, v242, 4, v240
s_and_b32 s31, s26, 1
s_lshl_b32 s31, s31, 13
s_sub_u32 s31, s22, s31
s_add_u32 s31, s31, 32768
buffer_load_dwordx4 v[224:227], v240, s[4:7], s31 offen offset:0 sc1
buffer_load_dwordx4 v[228:231], v240, s[4:7], s31 offen offset:128 sc1
v_lshlrev_b32_sdwa v2, 3, v132 dst_sel:DWORD dst_unused:UNUSED_PAD src0_sel:DWORD src1_sel:WORD_1
v_lshlrev_b32_sdwa v132, 3, v132 dst_sel:DWORD dst_unused:UNUSED_PAD src0_sel:DWORD src1_sel:WORD_0
v_lshlrev_b32_sdwa v3, 3, v133 dst_sel:DWORD dst_unused:UNUSED_PAD src0_sel:DWORD src1_sel:WORD_1
v_lshlrev_b32_sdwa v133, 3, v133 dst_sel:DWORD dst_unused:UNUSED_PAD src0_sel:DWORD src1_sel:WORD_0
ds_read_b64 v[24:25], v132
ds_read_b64 v[26:27], v2
ds_read_b64 v[28:29], v133
ds_read_b64 v[30:31], v3
s_add_u32 s30, s20, 73728
buffer_load_dwordx4 v[164:167], v0, s[4:7], s30 offen offset:128 sc1
v_lshlrev_b32_sdwa v2, 3, v134 dst_sel:DWORD dst_unused:UNUSED_PAD src0_sel:DWORD src1_sel:WORD_1
v_lshlrev_b32_sdwa v134, 3, v134 dst_sel:DWORD dst_unused:UNUSED_PAD src0_sel:DWORD src1_sel:WORD_0
v_lshlrev_b32_sdwa v3, 3, v135 dst_sel:DWORD dst_unused:UNUSED_PAD src0_sel:DWORD src1_sel:WORD_1
v_lshlrev_b32_sdwa v135, 3, v135 dst_sel:DWORD dst_unused:UNUSED_PAD src0_sel:DWORD src1_sel:WORD_0
s_waitcnt lgkmcnt(8)
v_smfmac_f32_16x16x64_bf16 v[96:99], v[4:7], v[8:15], v1
ds_read_b64 v[8:9], v134
ds_read_b64 v[10:11], v2
ds_read_b64 v[12:13], v135
ds_read_b64 v[14:15], v3
s_waitcnt vmcnt(8)
v_lshlrev_b32_sdwa v2, 3, v136 dst_sel:DWORD dst_unused:UNUSED_PAD src0_sel:DWORD src1_sel:WORD_1
v_lshlrev_b32_sdwa v136, 3, v136 dst_sel:DWORD dst_unused:UNUSED_PAD src0_sel:DWORD src1_sel:WORD_0
v_lshlrev_b32_sdwa v3, 3, v137 dst_sel:DWORD dst_unused:UNUSED_PAD src0_sel:DWORD src1_sel:WORD_1
v_lshlrev_b32_sdwa v137, 3, v137 dst_sel:DWORD dst_unused:UNUSED_PAD src0_sel:DWORD src1_sel:WORD_0
s_waitcnt lgkmcnt(8)
v_smfmac_f32_16x16x64_bf16 v[96:99], v[4:7], v[16:23], v1
ds_read_b64 v[16:17], v136
ds_read_b64 v[18:19], v2
ds_read_b64 v[20:21], v137
ds_read_b64 v[22:23], v3
s_add_u32 s30, s20, 73728
buffer_load_dwordx4 v[168:171], v0, s[4:7], s30 offen offset:256 sc1
v_lshlrev_b32_sdwa v2, 3, v138 dst_sel:DWORD dst_unused:UNUSED_PAD src0_sel:DWORD src1_sel:WORD_1
v_lshlrev_b32_sdwa v138, 3, v138 dst_sel:DWORD dst_unused:UNUSED_PAD src0_sel:DWORD src1_sel:WORD_0
v_lshlrev_b32_sdwa v3, 3, v139 dst_sel:DWORD dst_unused:UNUSED_PAD src0_sel:DWORD src1_sel:WORD_1
v_lshlrev_b32_sdwa v139, 3, v139 dst_sel:DWORD dst_unused:UNUSED_PAD src0_sel:DWORD src1_sel:WORD_0
s_waitcnt lgkmcnt(8)
v_smfmac_f32_16x16x64_bf16 v[96:99], v[4:7], v[24:31], v1
ds_read_b64 v[24:25], v138
ds_read_b64 v[26:27], v2
ds_read_b64 v[28:29], v139
ds_read_b64 v[30:31], v3
v_lshlrev_b32_sdwa v2, 3, v140 dst_sel:DWORD dst_unused:UNUSED_PAD src0_sel:DWORD src1_sel:WORD_1
v_lshlrev_b32_sdwa v140, 3, v140 dst_sel:DWORD dst_unused:UNUSED_PAD src0_sel:DWORD src1_sel:WORD_0
v_lshlrev_b32_sdwa v3, 3, v141 dst_sel:DWORD dst_unused:UNUSED_PAD src0_sel:DWORD src1_sel:WORD_1
v_lshlrev_b32_sdwa v141, 3, v141 dst_sel:DWORD dst_unused:UNUSED_PAD src0_sel:DWORD src1_sel:WORD_0
s_waitcnt lgkmcnt(8)
v_smfmac_f32_16x16x64_bf16 v[96:99], v[4:7], v[8:15], v1
ds_read_b64 v[8:9], v140
ds_read_b64 v[10:11], v2
ds_read_b64 v[12:13], v141
ds_read_b64 v[14:15], v3
s_add_u32 s30, s20, 73728
buffer_load_dwordx4 v[172:175], v0, s[4:7], s30 offen offset:384 sc1
v_lshlrev_b32_sdwa v2, 3, v142 dst_sel:DWORD dst_unused:UNUSED_PAD src0_sel:DWORD src1_sel:WORD_1
v_lshlrev_b32_sdwa v142, 3, v142 dst_sel:DWORD dst_unused:UNUSED_PAD src0_sel:DWORD src1_sel:WORD_0
v_lshlrev_b32_sdwa v3, 3, v143 dst_sel:DWORD dst_unused:UNUSED_PAD src0_sel:DWORD src1_sel:WORD_1
v_lshlrev_b32_sdwa v143, 3, v143 dst_sel:DWORD dst_unused:UNUSED_PAD src0_sel:DWORD src1_sel:WORD_0
s_waitcnt lgkmcnt(8)
v_smfmac_f32_16x16x64_bf16 v[100:103], v[4:7], v[16:23], v1
ds_read_b64 v[16:17], v142
ds_read_b64 v[18:19], v2
ds_read_b64 v[20:21], v143
ds_read_b64 v[22:23], v3
s_waitcnt vmcnt(8)
v_lshlrev_b32_sdwa v2, 3, v144 dst_sel:DWORD dst_unused:UNUSED_PAD src0_sel:DWORD src1_sel:WORD_1
v_lshlrev_b32_sdwa v144, 3, v144 dst_sel:DWORD dst_unused:UNUSED_PAD src0_sel:DWORD src1_sel:WORD_0
v_lshlrev_b32_sdwa v3, 3, v145 dst_sel:DWORD dst_unused:UNUSED_PAD src0_sel:DWORD src1_sel:WORD_1
v_lshlrev_b32_sdwa v145, 3, v145 dst_sel:DWORD dst_unused:UNUSED_PAD src0_sel:DWORD src1_sel:WORD_0
s_waitcnt vmcnt(3)
v_permlane16_swap_b32 v224, v232
v_permlane16_swap_b32 v225, v233
v_permlane16_swap_b32 v226, v234
v_permlane16_swap_b32 v227, v235
v_permlane16_swap_b32 v228, v236
v_permlane16_swap_b32 v229, v237
v_permlane16_swap_b32 v230, v238
v_permlane16_swap_b32 v231, v239
s_waitcnt lgkmcnt(8)
v_smfmac_f32_16x16x64_bf16 v[100:103], v[4:7], v[24:31], v1
ds_read_b64 v[24:25], v144
ds_read_b64 v[26:27], v2
ds_read_b64 v[28:29], v145
ds_read_b64 v[30:31], v3
s_add_u32 s30, s20, 73728
buffer_load_dwordx4 v[176:179], v0, s[4:7], s30 offen offset:512 sc1
v_lshlrev_b32_sdwa v2, 3, v146 dst_sel:DWORD dst_unused:UNUSED_PAD src0_sel:DWORD src1_sel:WORD_1
v_lshlrev_b32_sdwa v146, 3, v146 dst_sel:DWORD dst_unused:UNUSED_PAD src0_sel:DWORD src1_sel:WORD_0
v_lshlrev_b32_sdwa v3, 3, v147 dst_sel:DWORD dst_unused:UNUSED_PAD src0_sel:DWORD src1_sel:WORD_1
v_lshlrev_b32_sdwa v147, 3, v147 dst_sel:DWORD dst_unused:UNUSED_PAD src0_sel:DWORD src1_sel:WORD_0
v_and_b32 v240, 24, v241
v_and_b32 v242, 3, v241
v_lshl_add_u32 v240, v242, 1, v240
v_bfe_u32 v242, v241, 2, 1
v_add_u32 v240, v240, v242
v_lshrrev_b32 v242, 5, v241
v_lshl_add_u32 v240, v240, 1, v242
s_lshl_b32 s30, s3, 10
s_add_u32 s30, s30, 131072
v_lshl_add_u32 v240, v240, 4, s30
s_waitcnt lgkmcnt(8)
v_smfmac_f32_16x16x64_bf16 v[100:103], v[4:7], v[8:15], v1
ds_read_b64 v[8:9], v146
ds_read_b64 v[10:11], v2
ds_read_b64 v[12:13], v147
ds_read_b64 v[14:15], v3
v_mfma_f32_32x32x16_bf16 v[192:207], v[224:227], v[64:67], 0
v_lshlrev_b32_sdwa v2, 3, v148 dst_sel:DWORD dst_unused:UNUSED_PAD src0_sel:DWORD src1_sel:WORD_1
v_lshlrev_b32_sdwa v148, 3, v148 dst_sel:DWORD dst_unused:UNUSED_PAD src0_sel:DWORD src1_sel:WORD_0
v_lshlrev_b32_sdwa v3, 3, v149 dst_sel:DWORD dst_unused:UNUSED_PAD src0_sel:DWORD src1_sel:WORD_1
v_lshlrev_b32_sdwa v149, 3, v149 dst_sel:DWORD dst_unused:UNUSED_PAD src0_sel:DWORD src1_sel:WORD_0
s_waitcnt lgkmcnt(8)
v_smfmac_f32_16x16x64_bf16 v[100:103], v[4:7], v[16:23], v1
ds_read_b64 v[16:17], v148
ds_read_b64 v[18:19], v2
ds_read_b64 v[20:21], v149
ds_read_b64 v[22:23], v3
v_mfma_f32_32x32x16_bf16 v[192:207], v[228:231], v[68:71], v[192:207]
s_add_u32 s30, s20, 73728
buffer_load_dwordx4 v[180:183], v0, s[4:7], s30 offen offset:640 sc1
v_lshlrev_b32_sdwa v2, 3, v150 dst_sel:DWORD dst_unused:UNUSED_PAD src0_sel:DWORD src1_sel:WORD_1
v_lshlrev_b32_sdwa v150, 3, v150 dst_sel:DWORD dst_unused:UNUSED_PAD src0_sel:DWORD src1_sel:WORD_0
v_lshlrev_b32_sdwa v3, 3, v151 dst_sel:DWORD dst_unused:UNUSED_PAD src0_sel:DWORD src1_sel:WORD_1
v_lshlrev_b32_sdwa v151, 3, v151 dst_sel:DWORD dst_unused:UNUSED_PAD src0_sel:DWORD src1_sel:WORD_0
s_waitcnt lgkmcnt(8)
v_smfmac_f32_16x16x64_bf16 v[104:107], v[4:7], v[24:31], v1
ds_read_b64 v[24:25], v150
ds_read_b64 v[26:27], v2
ds_read_b64 v[28:29], v151
ds_read_b64 v[30:31], v3
v_mfma_f32_32x32x16_bf16 v[192:207], v[232:235], v[72:75], v[192:207]
s_waitcnt vmcnt(8)
v_lshlrev_b32_sdwa v2, 3, v152 dst_sel:DWORD dst_unused:UNUSED_PAD src0_sel:DWORD src1_sel:WORD_1
v_lshlrev_b32_sdwa v152, 3, v152 dst_sel:DWORD dst_unused:UNUSED_PAD src0_sel:DWORD src1_sel:WORD_0
v_lshlrev_b32_sdwa v3, 3, v153 dst_sel:DWORD dst_unused:UNUSED_PAD src0_sel:DWORD src1_sel:WORD_1
v_lshlrev_b32_sdwa v153, 3, v153 dst_sel:DWORD dst_unused:UNUSED_PAD src0_sel:DWORD src1_sel:WORD_0
s_waitcnt lgkmcnt(8)
v_smfmac_f32_16x16x64_bf16 v[104:107], v[4:7], v[8:15], v1
ds_read_b64 v[8:9], v152
ds_read_b64 v[10:11], v2
ds_read_b64 v[12:13], v153
ds_read_b64 v[14:15], v3
v_mfma_f32_32x32x16_bf16 v[192:207], v[236:239], v[76:79], v[192:207]
s_add_u32 s30, s20, 73728
buffer_load_dwordx4 v[184:187], v0, s[4:7], s30 offen offset:768 sc1
v_lshlrev_b32_sdwa v2, 3, v154 dst_sel:DWORD dst_unused:UNUSED_PAD src0_sel:DWORD src1_sel:WORD_1
v_lshlrev_b32_sdwa v154, 3, v154 dst_sel:DWORD dst_unused:UNUSED_PAD src0_sel:DWORD src1_sel:WORD_0
v_lshlrev_b32_sdwa v3, 3, v155 dst_sel:DWORD dst_unused:UNUSED_PAD src0_sel:DWORD src1_sel:WORD_1
v_lshlrev_b32_sdwa v155, 3, v155 dst_sel:DWORD dst_unused:UNUSED_PAD src0_sel:DWORD src1_sel:WORD_0
v_cvt_pk_bf16_f32 v96, v96, v97
v_cvt_pk_bf16_f32 v97, v98, v99
v_cvt_pk_bf16_f32 v98, v100, v101
v_cvt_pk_bf16_f32 v99, v102, v102
v_mov_b32_sdwa v99, s29 dst_sel:WORD_1 dst_unused:UNUSED_PRESERVE src0_sel:WORD_1
s_nop 0
buffer_store_dwordx4 v[96:99], v0, s[4:7], s55 offen offset:0 sc1
s_waitcnt lgkmcnt(8)
v_smfmac_f32_16x16x64_bf16 v[104:107], v[4:7], v[16:23], v1
ds_read_b64 v[16:17], v154
ds_read_b64 v[18:19], v2
ds_read_b64 v[20:21], v155
ds_read_b64 v[22:23], v3
v_mfma_f32_32x32x16_bf16 v[208:223], v[224:227], v[80:83], 0
v_lshlrev_b32_sdwa v2, 3, v156 dst_sel:DWORD dst_unused:UNUSED_PAD src0_sel:DWORD src1_sel:WORD_1
v_lshlrev_b32_sdwa v156, 3, v156 dst_sel:DWORD dst_unused:UNUSED_PAD src0_sel:DWORD src1_sel:WORD_0
v_lshlrev_b32_sdwa v3, 3, v157 dst_sel:DWORD dst_unused:UNUSED_PAD src0_sel:DWORD src1_sel:WORD_1
v_lshlrev_b32_sdwa v157, 3, v157 dst_sel:DWORD dst_unused:UNUSED_PAD src0_sel:DWORD src1_sel:WORD_0
s_waitcnt lgkmcnt(8)
v_smfmac_f32_16x16x64_bf16 v[104:107], v[4:7], v[24:31], v1
ds_read_b64 v[24:25], v156
ds_read_b64 v[26:27], v2
ds_read_b64 v[28:29], v157
ds_read_b64 v[30:31], v3
v_mfma_f32_32x32x16_bf16 v[208:223], v[228:231], v[84:87], v[208:223]
s_add_u32 s30, s20, 73728
buffer_load_dwordx4 v[188:191], v0, s[4:7], s30 offen offset:896 sc1
v_lshlrev_b32_sdwa v2, 3, v158 dst_sel:DWORD dst_unused:UNUSED_PAD src0_sel:DWORD src1_sel:WORD_1
v_lshlrev_b32_sdwa v158, 3, v158 dst_sel:DWORD dst_unused:UNUSED_PAD src0_sel:DWORD src1_sel:WORD_0
v_lshlrev_b32_sdwa v3, 3, v159 dst_sel:DWORD dst_unused:UNUSED_PAD src0_sel:DWORD src1_sel:WORD_1
v_lshlrev_b32_sdwa v159, 3, v159 dst_sel:DWORD dst_unused:UNUSED_PAD src0_sel:DWORD src1_sel:WORD_0
v_cvt_pk_bf16_f32 v192, v192, v196
v_cvt_pk_bf16_f32 v193, v193, v197
v_cvt_pk_bf16_f32 v194, v194, v198
v_cvt_pk_bf16_f32 v195, v195, v199
ds_write_b128 v240, v[192:195] offset:0
s_waitcnt lgkmcnt(8)
v_smfmac_f32_16x16x64_bf16 v[108:111], v[4:7], v[8:15], v1
ds_read_b64 v[8:9], v158
ds_read_b64 v[10:11], v2
ds_read_b64 v[12:13], v159
ds_read_b64 v[14:15], v3
v_mfma_f32_32x32x16_bf16 v[208:223], v[232:235], v[88:91], v[208:223]
s_add_u32 s30, s21, 65536
buffer_load_dwordx4 v[128:131], v0, s[4:7], s30 offen offset:0 sc1
s_waitcnt vmcnt(8)
v_lshlrev_b32_sdwa v2, 3, v160 dst_sel:DWORD dst_unused:UNUSED_PAD src0_sel:DWORD src1_sel:WORD_1
v_lshlrev_b32_sdwa v160, 3, v160 dst_sel:DWORD dst_unused:UNUSED_PAD src0_sel:DWORD src1_sel:WORD_0
v_lshlrev_b32_sdwa v3, 3, v161 dst_sel:DWORD dst_unused:UNUSED_PAD src0_sel:DWORD src1_sel:WORD_1
v_lshlrev_b32_sdwa v161, 3, v161 dst_sel:DWORD dst_unused:UNUSED_PAD src0_sel:DWORD src1_sel:WORD_0
s_waitcnt lgkmcnt(8)
v_smfmac_f32_16x16x64_bf16 v[108:111], v[4:7], v[16:23], v1
ds_read_b64 v[16:17], v160
ds_read_b64 v[18:19], v2
ds_read_b64 v[20:21], v161
ds_read_b64 v[22:23], v3
v_mfma_f32_32x32x16_bf16 v[208:223], v[236:239], v[92:95], v[208:223]
s_add_u32 s30, s21, 65536
buffer_load_dwordx4 v[132:135], v0, s[4:7], s30 offen offset:128 sc1
v_lshlrev_b32_sdwa v2, 3, v162 dst_sel:DWORD dst_unused:UNUSED_PAD src0_sel:DWORD src1_sel:WORD_1
v_lshlrev_b32_sdwa v162, 3, v162 dst_sel:DWORD dst_unused:UNUSED_PAD src0_sel:DWORD src1_sel:WORD_0
v_lshlrev_b32_sdwa v3, 3, v163 dst_sel:DWORD dst_unused:UNUSED_PAD src0_sel:DWORD src1_sel:WORD_1
v_lshlrev_b32_sdwa v163, 3, v163 dst_sel:DWORD dst_unused:UNUSED_PAD src0_sel:DWORD src1_sel:WORD_0
s_waitcnt lgkmcnt(8)
v_smfmac_f32_16x16x64_bf16 v[108:111], v[4:7], v[24:31], v1
ds_read_b64 v[24:25], v162
ds_read_b64 v[26:27], v2
ds_read_b64 v[28:29], v163
ds_read_b64 v[30:31], v3
s_add_u32 s30, s21, 65536
buffer_load_dwordx4 v[136:139], v0, s[4:7], s30 offen offset:256 sc1
v_lshlrev_b32_sdwa v2, 3, v164 dst_sel:DWORD dst_unused:UNUSED_PAD src0_sel:DWORD src1_sel:WORD_1
v_lshlrev_b32_sdwa v164, 3, v164 dst_sel:DWORD dst_unused:UNUSED_PAD src0_sel:DWORD src1_sel:WORD_0
v_lshlrev_b32_sdwa v3, 3, v165 dst_sel:DWORD dst_unused:UNUSED_PAD src0_sel:DWORD src1_sel:WORD_1
v_lshlrev_b32_sdwa v165, 3, v165 dst_sel:DWORD dst_unused:UNUSED_PAD src0_sel:DWORD src1_sel:WORD_0
s_waitcnt lgkmcnt(8)
v_smfmac_f32_16x16x64_bf16 v[108:111], v[4:7], v[8:15], v1
ds_read_b64 v[8:9], v164
ds_read_b64 v[10:11], v2
ds_read_b64 v[12:13], v165
ds_read_b64 v[14:15], v3
s_add_u32 s30, s21, 65536
buffer_load_dwordx4 v[140:143], v0, s[4:7], s30 offen offset:384 sc1
v_lshlrev_b32_sdwa v2, 3, v166 dst_sel:DWORD dst_unused:UNUSED_PAD src0_sel:DWORD src1_sel:WORD_1
v_lshlrev_b32_sdwa v166, 3, v166 dst_sel:DWORD dst_unused:UNUSED_PAD src0_sel:DWORD src1_sel:WORD_0
v_lshlrev_b32_sdwa v3, 3, v167 dst_sel:DWORD dst_unused:UNUSED_PAD src0_sel:DWORD src1_sel:WORD_1
v_lshlrev_b32_sdwa v167, 3, v167 dst_sel:DWORD dst_unused:UNUSED_PAD src0_sel:DWORD src1_sel:WORD_0
v_cvt_pk_bf16_f32 v208, v208, v212
v_cvt_pk_bf16_f32 v209, v209, v213
v_cvt_pk_bf16_f32 v210, v210, v214
v_cvt_pk_bf16_f32 v211, v211, v215
ds_write_b128 v240, v[208:211] offset:8192
s_waitcnt lgkmcnt(8)
v_smfmac_f32_16x16x64_bf16 v[112:115], v[4:7], v[16:23], v1
ds_read_b64 v[16:17], v166
ds_read_b64 v[18:19], v2
ds_read_b64 v[20:21], v167
ds_read_b64 v[22:23], v3
s_waitcnt vmcnt(9)
v_lshlrev_b32_sdwa v2, 3, v168 dst_sel:DWORD dst_unused:UNUSED_PAD src0_sel:DWORD src1_sel:WORD_1
v_lshlrev_b32_sdwa v168, 3, v168 dst_sel:DWORD dst_unused:UNUSED_PAD src0_sel:DWORD src1_sel:WORD_0
v_lshlrev_b32_sdwa v3, 3, v169 dst_sel:DWORD dst_unused:UNUSED_PAD src0_sel:DWORD src1_sel:WORD_1
v_lshlrev_b32_sdwa v169, 3, v169 dst_sel:DWORD dst_unused:UNUSED_PAD src0_sel:DWORD src1_sel:WORD_0
v_mbcnt_lo_u32_b32 v64, -1, 0
v_mbcnt_hi_u32_b32 v64, -1, v64
v_lshlrev_b32 v94, 4, v64
s_and_b32 s31, s26, 1
s_lshl_b32 s31, s31, 14
s_sub_u32 s20, s21, s31
s_add_u32 s20, s20, 98304
v_and_b32 v69, 15, v64
v_lshlrev_b32 v69, 4, v69
v_lshrrev_b32 v68, 4, v64
v_lshl_or_b32 v68, v68, 14, v69
s_lshl_b32 s70, s26, 20
s_lshl_b32 s71, s3, 17
s_add_u32 s70, s70, s71
s_lshl_b32 s71, s27, 8
s_add_u32 s70, s70, s71
s_add_u32 s70, s70, 0x600000
s_add_u32 s71, s70, 65536
s_and_b32 s31, s29, 255
v_mov_b32 v70, s31
s_mov_b32 s22, 0xffffff00
s_lshl_b32 s56, s58, 16
s_and_b32 s57, s58, 0xffff0000
s_lshl_b32 s58, s59, 16
s_and_b32 s59, s59, 0xffff0000
s_xor_b32 s52, s52, 0x80008000
s_xor_b32 s53, s53, 0x80008000
s_lshl_b32 s0, s52, 16
s_and_b32 s1, s52, 0xffff0000
s_lshl_b32 s52, s53, 16
s_and_b32 s53, s53, 0xffff0000
v_mov_b32 v69, s0
v_mul_f32 v67, s56, v69
v_mov_b32 v69, s1
v_fma_f32 v67, v69, s57, v67
v_mov_b32 v69, s52
v_fma_f32 v67, v69, s58, v67
v_mov_b32 v69, s53
v_fma_f32 v67, v69, s59, v67
v_xor_b32 v67, 0x80000000, v67
s_mov_b32 s8, s36
s_mov_b32 s9, s37
s_mov_b32 s10, 0x68000
s_mov_b32 s11, 0x20000
s_mov_b32 s12, s50
s_mov_b32 s13, s51
s_mov_b32 s14, 0x8000
s_mov_b32 s15, 0x20000
s_waitcnt lgkmcnt(8)
v_smfmac_f32_16x16x64_bf16 v[112:115], v[4:7], v[24:31], v1
ds_read_b64 v[24:25], v168
ds_read_b64 v[26:27], v2
ds_read_b64 v[28:29], v169
ds_read_b64 v[30:31], v3
v_lshlrev_b32_sdwa v2, 3, v170 dst_sel:DWORD dst_unused:UNUSED_PAD src0_sel:DWORD src1_sel:WORD_1
v_lshlrev_b32_sdwa v170, 3, v170 dst_sel:DWORD dst_unused:UNUSED_PAD src0_sel:DWORD src1_sel:WORD_0
v_lshlrev_b32_sdwa v3, 3, v171 dst_sel:DWORD dst_unused:UNUSED_PAD src0_sel:DWORD src1_sel:WORD_1
v_lshlrev_b32_sdwa v171, 3, v171 dst_sel:DWORD dst_unused:UNUSED_PAD src0_sel:DWORD src1_sel:WORD_0
v_cvt_pk_bf16_f32 v104, v103, v104
v_cvt_pk_bf16_f32 v105, v105, v106
v_cvt_pk_bf16_f32 v106, v107, v108
v_cvt_pk_bf16_f32 v107, v109, v109
v_mov_b32_sdwa v107, s29 dst_sel:WORD_1 dst_unused:UNUSED_PRESERVE src0_sel:WORD_1
s_nop 0
buffer_store_dwordx4 v[104:107], v0, s[4:7], s55 offen offset:128 sc1
s_waitcnt lgkmcnt(8)
v_smfmac_f32_16x16x64_bf16 v[112:115], v[4:7], v[8:15], v1
ds_read_b64 v[8:9], v170
ds_read_b64 v[10:11], v2
ds_read_b64 v[12:13], v171
ds_read_b64 v[14:15], v3
buffer_load_dwordx4 v[240:243], v94, s[4:7], s20 offen offset:0 sc1
v_lshlrev_b32_sdwa v2, 3, v172 dst_sel:DWORD dst_unused:UNUSED_PAD src0_sel:DWORD src1_sel:WORD_1
v_lshlrev_b32_sdwa v172, 3, v172 dst_sel:DWORD dst_unused:UNUSED_PAD src0_sel:DWORD src1_sel:WORD_0
v_lshlrev_b32_sdwa v3, 3, v173 dst_sel:DWORD dst_unused:UNUSED_PAD src0_sel:DWORD src1_sel:WORD_1
v_lshlrev_b32_sdwa v173, 3, v173 dst_sel:DWORD dst_unused:UNUSED_PAD src0_sel:DWORD src1_sel:WORD_0
s_waitcnt lgkmcnt(8)
v_smfmac_f32_16x16x64_bf16 v[112:115], v[4:7], v[16:23], v1
ds_read_b64 v[16:17], v172
ds_read_b64 v[18:19], v2
ds_read_b64 v[20:21], v173
ds_read_b64 v[22:23], v3
s_add_u32 s30, s21, 65536
buffer_load_dwordx4 v[144:147], v0, s[4:7], s30 offen offset:512 sc1
v_lshlrev_b32_sdwa v2, 3, v174 dst_sel:DWORD dst_unused:UNUSED_PAD src0_sel:DWORD src1_sel:WORD_1
v_lshlrev_b32_sdwa v174, 3, v174 dst_sel:DWORD dst_unused:UNUSED_PAD src0_sel:DWORD src1_sel:WORD_0
v_lshlrev_b32_sdwa v3, 3, v175 dst_sel:DWORD dst_unused:UNUSED_PAD src0_sel:DWORD src1_sel:WORD_1
v_lshlrev_b32_sdwa v175, 3, v175 dst_sel:DWORD dst_unused:UNUSED_PAD src0_sel:DWORD src1_sel:WORD_0
s_waitcnt lgkmcnt(8)
v_smfmac_f32_16x16x64_bf16 v[116:119], v[4:7], v[24:31], v1
ds_read_b64 v[24:25], v174
ds_read_b64 v[26:27], v2
ds_read_b64 v[28:29], v175
ds_read_b64 v[30:31], v3
buffer_load_dwordx4 v[244:247], v94, s[4:7], s20 offen offset:1024 sc1
s_waitcnt vmcnt(11)
v_lshlrev_b32_sdwa v2, 3, v176 dst_sel:DWORD dst_unused:UNUSED_PAD src0_sel:DWORD src1_sel:WORD_1
v_lshlrev_b32_sdwa v176, 3, v176 dst_sel:DWORD dst_unused:UNUSED_PAD src0_sel:DWORD src1_sel:WORD_0
v_lshlrev_b32_sdwa v3, 3, v177 dst_sel:DWORD dst_unused:UNUSED_PAD src0_sel:DWORD src1_sel:WORD_1
v_lshlrev_b32_sdwa v177, 3, v177 dst_sel:DWORD dst_unused:UNUSED_PAD src0_sel:DWORD src1_sel:WORD_0
s_cmp_lg_u32 s3, 0
s_cbranch_scc1 nowide
s_lshr_b32 s30, s28, 2
s_lshl_b32 s30, s30, 8
s_and_b32 s31, s28, 3
s_lshl_b32 s31, s31, 4
s_add_u32 s30, s30, s31
v_lshrrev_b32 v65, 4, v64
v_and_b32 v66, 15, v64
v_lshl_add_u32 v65, v65, 6, v66
v_add_u32 v65, s30, v65
v_mul_u32_u24 v66, 26, v65
buffer_load_ushort v80, v66, s[8:11], 0 offen offset:0
buffer_load_ushort v81, v66, s[8:11], 0 offen offset:2
buffer_load_ushort v82, v66, s[8:11], 0 offen offset:4
buffer_load_ushort v83, v66, s[8:11], 0 offen offset:6
buffer_load_ushort v84, v66, s[8:11], 0 offen offset:8
buffer_load_ushort v85, v66, s[8:11], 0 offen offset:10
buffer_load_ushort v86, v66, s[8:11], 0 offen offset:12
buffer_load_ushort v87, v66, s[8:11], 0 offen offset:14
buffer_load_ushort v88, v66, s[8:11], 0 offen offset:16
buffer_load_ushort v89, v66, s[8:11], 0 offen offset:18
buffer_load_ushort v90, v66, s[8:11], 0 offen offset:20
buffer_load_ushort v91, v66, s[8:11], 0 offen offset:22
buffer_load_ushort v92, v66, s[8:11], 0 offen offset:24
nowide:
s_waitcnt lgkmcnt(8)
v_smfmac_f32_16x16x64_bf16 v[116:119], v[4:7], v[8:15], v1
s_barrier
ds_read_b64 v[8:9], v176
ds_read_b64 v[10:11], v2
ds_read_b64 v[12:13], v177
ds_read_b64 v[14:15], v3
s_add_u32 s30, s21, 65536
buffer_load_dwordx4 v[148:151], v0, s[4:7], s30 offen offset:640 sc1
v_lshlrev_b32_sdwa v2, 3, v178 dst_sel:DWORD dst_unused:UNUSED_PAD src0_sel:DWORD src1_sel:WORD_1
v_lshlrev_b32_sdwa v178, 3, v178 dst_sel:DWORD dst_unused:UNUSED_PAD src0_sel:DWORD src1_sel:WORD_0
v_lshlrev_b32_sdwa v3, 3, v179 dst_sel:DWORD dst_unused:UNUSED_PAD src0_sel:DWORD src1_sel:WORD_1
v_lshlrev_b32_sdwa v179, 3, v179 dst_sel:DWORD dst_unused:UNUSED_PAD src0_sel:DWORD src1_sel:WORD_0
s_waitcnt lgkmcnt(8)
v_smfmac_f32_16x16x64_bf16 v[116:119], v[4:7], v[16:23], v1
ds_read_b64 v[16:17], v178
ds_read_b64 v[18:19], v2
ds_read_b64 v[20:21], v179
ds_read_b64 v[22:23], v3
buffer_load_dwordx4 v[248:251], v94, s[4:7], s20 offen offset:2048 sc1
v_lshlrev_b32_sdwa v2, 3, v180 dst_sel:DWORD dst_unused:UNUSED_PAD src0_sel:DWORD src1_sel:WORD_1
v_lshlrev_b32_sdwa v180, 3, v180 dst_sel:DWORD dst_unused:UNUSED_PAD src0_sel:DWORD src1_sel:WORD_0
v_lshlrev_b32_sdwa v3, 3, v181 dst_sel:DWORD dst_unused:UNUSED_PAD src0_sel:DWORD src1_sel:WORD_1
v_lshlrev_b32_sdwa v181, 3, v181 dst_sel:DWORD dst_unused:UNUSED_PAD src0_sel:DWORD src1_sel:WORD_0
s_waitcnt lgkmcnt(8)
v_smfmac_f32_16x16x64_bf16 v[116:119], v[4:7], v[24:31], v1
ds_read_b64 v[24:25], v180
ds_read_b64 v[26:27], v2
ds_read_b64 v[28:29], v181
ds_read_b64 v[30:31], v3
s_add_u32 s30, s21, 65536
buffer_load_dwordx4 v[152:155], v0, s[4:7], s30 offen offset:768 sc1
v_lshlrev_b32_sdwa v2, 3, v182 dst_sel:DWORD dst_unused:UNUSED_PAD src0_sel:DWORD src1_sel:WORD_1
v_lshlrev_b32_sdwa v182, 3, v182 dst_sel:DWORD dst_unused:UNUSED_PAD src0_sel:DWORD src1_sel:WORD_0
v_lshlrev_b32_sdwa v3, 3, v183 dst_sel:DWORD dst_unused:UNUSED_PAD src0_sel:DWORD src1_sel:WORD_1
v_lshlrev_b32_sdwa v183, 3, v183 dst_sel:DWORD dst_unused:UNUSED_PAD src0_sel:DWORD src1_sel:WORD_0
s_waitcnt lgkmcnt(8)
v_smfmac_f32_16x16x64_bf16 v[120:123], v[4:7], v[8:15], v1
ds_read_b64 v[8:9], v182
ds_read_b64 v[10:11], v2
ds_read_b64 v[12:13], v183
ds_read_b64 v[14:15], v3
buffer_load_dwordx4 v[252:255], v94, s[4:7], s20 offen offset:3072 sc1
s_waitcnt vmcnt(12)
v_lshlrev_b32_sdwa v2, 3, v184 dst_sel:DWORD dst_unused:UNUSED_PAD src0_sel:DWORD src1_sel:WORD_1
v_lshlrev_b32_sdwa v184, 3, v184 dst_sel:DWORD dst_unused:UNUSED_PAD src0_sel:DWORD src1_sel:WORD_0
v_lshlrev_b32_sdwa v3, 3, v185 dst_sel:DWORD dst_unused:UNUSED_PAD src0_sel:DWORD src1_sel:WORD_1
v_lshlrev_b32_sdwa v185, 3, v185 dst_sel:DWORD dst_unused:UNUSED_PAD src0_sel:DWORD src1_sel:WORD_0
s_waitcnt lgkmcnt(8)
v_smfmac_f32_16x16x64_bf16 v[120:123], v[4:7], v[16:23], v1
ds_read_b64 v[16:17], v184
ds_read_b64 v[18:19], v2
ds_read_b64 v[20:21], v185
ds_read_b64 v[22:23], v3
v_lshlrev_b32_sdwa v2, 3, v186 dst_sel:DWORD dst_unused:UNUSED_PAD src0_sel:DWORD src1_sel:WORD_1
v_lshlrev_b32_sdwa v186, 3, v186 dst_sel:DWORD dst_unused:UNUSED_PAD src0_sel:DWORD src1_sel:WORD_0
v_lshlrev_b32_sdwa v3, 3, v187 dst_sel:DWORD dst_unused:UNUSED_PAD src0_sel:DWORD src1_sel:WORD_1
v_lshlrev_b32_sdwa v187, 3, v187 dst_sel:DWORD dst_unused:UNUSED_PAD src0_sel:DWORD src1_sel:WORD_0
v_cvt_pk_bf16_f32 v110, v110, v111
v_cvt_pk_bf16_f32 v111, v112, v113
v_cvt_pk_bf16_f32 v112, v114, v115
v_cvt_pk_bf16_f32 v113, v116, v116
v_mov_b32_sdwa v113, s29 dst_sel:WORD_1 dst_unused:UNUSED_PRESERVE src0_sel:WORD_1
s_nop 0
buffer_store_dwordx4 v[110:113], v0, s[4:7], s55 offen offset:256 sc1
s_waitcnt lgkmcnt(8)
v_smfmac_f32_16x16x64_bf16 v[120:123], v[4:7], v[24:31], v1
ds_read_b64 v[24:25], v186
ds_read_b64 v[26:27], v2
ds_read_b64 v[28:29], v187
ds_read_b64 v[30:31], v3
s_add_u32 s30, s21, 65536
buffer_load_dwordx4 v[156:159], v0, s[4:7], s30 offen offset:896 sc1
v_lshlrev_b32_sdwa v2, 3, v188 dst_sel:DWORD dst_unused:UNUSED_PAD src0_sel:DWORD src1_sel:WORD_1
v_lshlrev_b32_sdwa v188, 3, v188 dst_sel:DWORD dst_unused:UNUSED_PAD src0_sel:DWORD src1_sel:WORD_0
v_lshlrev_b32_sdwa v3, 3, v189 dst_sel:DWORD dst_unused:UNUSED_PAD src0_sel:DWORD src1_sel:WORD_1
v_lshlrev_b32_sdwa v189, 3, v189 dst_sel:DWORD dst_unused:UNUSED_PAD src0_sel:DWORD src1_sel:WORD_0
s_waitcnt lgkmcnt(8)
v_smfmac_f32_16x16x64_bf16 v[120:123], v[4:7], v[8:15], v1
ds_read_b64 v[8:9], v188
ds_read_b64 v[10:11], v2
ds_read_b64 v[12:13], v189
ds_read_b64 v[14:15], v3
s_add_u32 s30, s21, 73728
buffer_load_dwordx4 v[160:163], v0, s[4:7], s30 offen offset:0 sc1
v_lshlrev_b32_sdwa v2, 3, v190 dst_sel:DWORD dst_unused:UNUSED_PAD src0_sel:DWORD src1_sel:WORD_1
v_lshlrev_b32_sdwa v190, 3, v190 dst_sel:DWORD dst_unused:UNUSED_PAD src0_sel:DWORD src1_sel:WORD_0
v_lshlrev_b32_sdwa v3, 3, v191 dst_sel:DWORD dst_unused:UNUSED_PAD src0_sel:DWORD src1_sel:WORD_1
v_lshlrev_b32_sdwa v191, 3, v191 dst_sel:DWORD dst_unused:UNUSED_PAD src0_sel:DWORD src1_sel:WORD_0
s_waitcnt lgkmcnt(8)
v_smfmac_f32_16x16x64_bf16 v[124:127], v[4:7], v[16:23], v1
ds_read_b64 v[16:17], v190
ds_read_b64 v[18:19], v2
ds_read_b64 v[20:21], v191
ds_read_b64 v[22:23], v3
s_add_u32 s30, s21, 73728
buffer_load_dwordx4 v[164:167], v0, s[4:7], s30 offen offset:128 sc1
s_waitcnt vmcnt(14)
v_lshlrev_b32_sdwa v2, 3, v128 dst_sel:DWORD dst_unused:UNUSED_PAD src0_sel:DWORD src1_sel:WORD_1
v_lshlrev_b32_sdwa v128, 3, v128 dst_sel:DWORD dst_unused:UNUSED_PAD src0_sel:DWORD src1_sel:WORD_0
v_lshlrev_b32_sdwa v3, 3, v129 dst_sel:DWORD dst_unused:UNUSED_PAD src0_sel:DWORD src1_sel:WORD_1
v_lshlrev_b32_sdwa v129, 3, v129 dst_sel:DWORD dst_unused:UNUSED_PAD src0_sel:DWORD src1_sel:WORD_0
s_waitcnt lgkmcnt(8)
v_smfmac_f32_16x16x64_bf16 v[124:127], v[4:7], v[24:31], v1
ds_read_b64 v[24:25], v128
ds_read_b64 v[26:27], v2
ds_read_b64 v[28:29], v129
ds_read_b64 v[30:31], v3
v_lshlrev_b32_sdwa v2, 3, v130 dst_sel:DWORD dst_unused:UNUSED_PAD src0_sel:DWORD src1_sel:WORD_1
v_lshlrev_b32_sdwa v130, 3, v130 dst_sel:DWORD dst_unused:UNUSED_PAD src0_sel:DWORD src1_sel:WORD_0
v_lshlrev_b32_sdwa v3, 3, v131 dst_sel:DWORD dst_unused:UNUSED_PAD src0_sel:DWORD src1_sel:WORD_1
v_lshlrev_b32_sdwa v131, 3, v131 dst_sel:DWORD dst_unused:UNUSED_PAD src0_sel:DWORD src1_sel:WORD_0
v_cvt_pk_bf16_f32 v118, v117, v118
v_cvt_pk_bf16_f32 v119, v119, v120
v_cvt_pk_bf16_f32 v120, v121, v122
v_cvt_pk_bf16_f32 v121, v123, v123
v_mov_b32_sdwa v121, s29 dst_sel:WORD_1 dst_unused:UNUSED_PRESERVE src0_sel:WORD_1
s_nop 0
buffer_store_dwordx4 v[118:121], v0, s[4:7], s55 offen offset:384 sc1
s_waitcnt lgkmcnt(8)
v_smfmac_f32_16x16x64_bf16 v[124:127], v[4:7], v[8:15], v1
ds_read_b64 v[8:9], v130
ds_read_b64 v[10:11], v2
ds_read_b64 v[12:13], v131
ds_read_b64 v[14:15], v3
s_add_u32 s30, s21, 73728
buffer_load_dwordx4 v[168:171], v0, s[4:7], s30 offen offset:256 sc1
v_lshlrev_b32_sdwa v2, 3, v132 dst_sel:DWORD dst_unused:UNUSED_PAD src0_sel:DWORD src1_sel:WORD_1
v_lshlrev_b32_sdwa v132, 3, v132 dst_sel:DWORD dst_unused:UNUSED_PAD src0_sel:DWORD src1_sel:WORD_0
v_lshlrev_b32_sdwa v3, 3, v133 dst_sel:DWORD dst_unused:UNUSED_PAD src0_sel:DWORD src1_sel:WORD_1
v_lshlrev_b32_sdwa v133, 3, v133 dst_sel:DWORD dst_unused:UNUSED_PAD src0_sel:DWORD src1_sel:WORD_0
s_waitcnt lgkmcnt(8)
v_smfmac_f32_16x16x64_bf16 v[124:127], v[4:7], v[16:23], v1
ds_read_b64 v[16:17], v132
ds_read_b64 v[18:19], v2
ds_read_b64 v[20:21], v133
ds_read_b64 v[22:23], v3
s_add_u32 s30, s21, 73728
buffer_load_dwordx4 v[172:175], v0, s[4:7], s30 offen offset:384 sc1
v_lshlrev_b32_sdwa v2, 3, v134 dst_sel:DWORD dst_unused:UNUSED_PAD src0_sel:DWORD src1_sel:WORD_1
v_lshlrev_b32_sdwa v134, 3, v134 dst_sel:DWORD dst_unused:UNUSED_PAD src0_sel:DWORD src1_sel:WORD_0
v_lshlrev_b32_sdwa v3, 3, v135 dst_sel:DWORD dst_unused:UNUSED_PAD src0_sel:DWORD src1_sel:WORD_1
v_lshlrev_b32_sdwa v135, 3, v135 dst_sel:DWORD dst_unused:UNUSED_PAD src0_sel:DWORD src1_sel:WORD_0
s_waitcnt lgkmcnt(8)
v_smfmac_f32_16x16x64_bf16 v[32:35], v[4:7], v[24:31], v1
ds_read_b64 v[24:25], v134
ds_read_b64 v[26:27], v2
ds_read_b64 v[28:29], v135
ds_read_b64 v[30:31], v3
s_add_u32 s30, s21, 73728
buffer_load_dwordx4 v[176:179], v0, s[4:7], s30 offen offset:512 sc1
s_waitcnt vmcnt(16)
v_lshlrev_b32_sdwa v2, 3, v136 dst_sel:DWORD dst_unused:UNUSED_PAD src0_sel:DWORD src1_sel:WORD_1
v_lshlrev_b32_sdwa v136, 3, v136 dst_sel:DWORD dst_unused:UNUSED_PAD src0_sel:DWORD src1_sel:WORD_0
v_lshlrev_b32_sdwa v3, 3, v137 dst_sel:DWORD dst_unused:UNUSED_PAD src0_sel:DWORD src1_sel:WORD_1
v_lshlrev_b32_sdwa v137, 3, v137 dst_sel:DWORD dst_unused:UNUSED_PAD src0_sel:DWORD src1_sel:WORD_0
s_waitcnt lgkmcnt(8)
v_smfmac_f32_16x16x64_bf16 v[32:35], v[4:7], v[8:15], v1
ds_read_b64 v[8:9], v136
ds_read_b64 v[10:11], v2
ds_read_b64 v[12:13], v137
ds_read_b64 v[14:15], v3
v_lshlrev_b32_sdwa v2, 3, v138 dst_sel:DWORD dst_unused:UNUSED_PAD src0_sel:DWORD src1_sel:WORD_1
v_lshlrev_b32_sdwa v138, 3, v138 dst_sel:DWORD dst_unused:UNUSED_PAD src0_sel:DWORD src1_sel:WORD_0
v_lshlrev_b32_sdwa v3, 3, v139 dst_sel:DWORD dst_unused:UNUSED_PAD src0_sel:DWORD src1_sel:WORD_1
v_lshlrev_b32_sdwa v139, 3, v139 dst_sel:DWORD dst_unused:UNUSED_PAD src0_sel:DWORD src1_sel:WORD_0
v_mov_b32_sdwa v124, s29 dst_sel:BYTE_0 dst_unused:UNUSED_PRESERVE src0_sel:BYTE_0
v_mov_b32_sdwa v125, s29 dst_sel:BYTE_0 dst_unused:UNUSED_PRESERVE src0_sel:BYTE_0
v_mov_b32_sdwa v126, s29 dst_sel:BYTE_0 dst_unused:UNUSED_PRESERVE src0_sel:BYTE_0
v_mov_b32_sdwa v127, s29 dst_sel:BYTE_0 dst_unused:UNUSED_PRESERVE src0_sel:BYTE_0
s_nop 0
buffer_store_dwordx4 v[124:127], v0, s[4:7], s55 offen offset:512 sc1
s_waitcnt lgkmcnt(8)
v_smfmac_f32_16x16x64_bf16 v[32:35], v[4:7], v[16:23], v1
ds_read_b64 v[16:17], v138
ds_read_b64 v[18:19], v2
ds_read_b64 v[20:21], v139
ds_read_b64 v[22:23], v3
s_add_u32 s30, s21, 73728
buffer_load_dwordx4 v[180:183], v0, s[4:7], s30 offen offset:640 sc1
v_lshlrev_b32_sdwa v2, 3, v140 dst_sel:DWORD dst_unused:UNUSED_PAD src0_sel:DWORD src1_sel:WORD_1
v_lshlrev_b32_sdwa v140, 3, v140 dst_sel:DWORD dst_unused:UNUSED_PAD src0_sel:DWORD src1_sel:WORD_0
v_lshlrev_b32_sdwa v3, 3, v141 dst_sel:DWORD dst_unused:UNUSED_PAD src0_sel:DWORD src1_sel:WORD_1
v_lshlrev_b32_sdwa v141, 3, v141 dst_sel:DWORD dst_unused:UNUSED_PAD src0_sel:DWORD src1_sel:WORD_0
s_waitcnt lgkmcnt(8)
v_smfmac_f32_16x16x64_bf16 v[32:35], v[4:7], v[24:31], v1
ds_read_b64 v[24:25], v140
ds_read_b64 v[26:27], v2
ds_read_b64 v[28:29], v141
ds_read_b64 v[30:31], v3
s_add_u32 s30, s21, 73728
buffer_load_dwordx4 v[184:187], v0, s[4:7], s30 offen offset:768 sc1
v_lshlrev_b32_sdwa v2, 3, v142 dst_sel:DWORD dst_unused:UNUSED_PAD src0_sel:DWORD src1_sel:WORD_1
v_lshlrev_b32_sdwa v142, 3, v142 dst_sel:DWORD dst_unused:UNUSED_PAD src0_sel:DWORD src1_sel:WORD_0
v_lshlrev_b32_sdwa v3, 3, v143 dst_sel:DWORD dst_unused:UNUSED_PAD src0_sel:DWORD src1_sel:WORD_1
v_lshlrev_b32_sdwa v143, 3, v143 dst_sel:DWORD dst_unused:UNUSED_PAD src0_sel:DWORD src1_sel:WORD_0
s_waitcnt lgkmcnt(8)
v_smfmac_f32_16x16x64_bf16 v[36:39], v[4:7], v[8:15], v1
ds_read_b64 v[8:9], v142
ds_read_b64 v[10:11], v2
ds_read_b64 v[12:13], v143
ds_read_b64 v[14:15], v3
s_add_u32 s30, s21, 73728
buffer_load_dwordx4 v[188:191], v0, s[4:7], s30 offen offset:896 sc1
s_waitcnt vmcnt(15)
v_lshlrev_b32_sdwa v2, 3, v144 dst_sel:DWORD dst_unused:UNUSED_PAD src0_sel:DWORD src1_sel:WORD_1
v_lshlrev_b32_sdwa v144, 3, v144 dst_sel:DWORD dst_unused:UNUSED_PAD src0_sel:DWORD src1_sel:WORD_0
v_lshlrev_b32_sdwa v3, 3, v145 dst_sel:DWORD dst_unused:UNUSED_PAD src0_sel:DWORD src1_sel:WORD_1
v_lshlrev_b32_sdwa v145, 3, v145 dst_sel:DWORD dst_unused:UNUSED_PAD src0_sel:DWORD src1_sel:WORD_0
s_waitcnt lgkmcnt(8)
v_smfmac_f32_16x16x64_bf16 v[36:39], v[4:7], v[16:23], v1
ds_read_b64 v[16:17], v144
ds_read_b64 v[18:19], v2
ds_read_b64 v[20:21], v145
ds_read_b64 v[22:23], v3
v_lshlrev_b32_sdwa v2, 3, v146 dst_sel:DWORD dst_unused:UNUSED_PAD src0_sel:DWORD src1_sel:WORD_1
v_lshlrev_b32_sdwa v146, 3, v146 dst_sel:DWORD dst_unused:UNUSED_PAD src0_sel:DWORD src1_sel:WORD_0
v_lshlrev_b32_sdwa v3, 3, v147 dst_sel:DWORD dst_unused:UNUSED_PAD src0_sel:DWORD src1_sel:WORD_1
v_lshlrev_b32_sdwa v147, 3, v147 dst_sel:DWORD dst_unused:UNUSED_PAD src0_sel:DWORD src1_sel:WORD_0
s_waitcnt lgkmcnt(8)
v_smfmac_f32_16x16x64_bf16 v[36:39], v[4:7], v[24:31], v1
ds_read_b64 v[24:25], v146
ds_read_b64 v[26:27], v2
ds_read_b64 v[28:29], v147
ds_read_b64 v[30:31], v3
v_lshlrev_b32_sdwa v2, 3, v148 dst_sel:DWORD dst_unused:UNUSED_PAD src0_sel:DWORD src1_sel:WORD_1
v_lshlrev_b32_sdwa v148, 3, v148 dst_sel:DWORD dst_unused:UNUSED_PAD src0_sel:DWORD src1_sel:WORD_0
v_lshlrev_b32_sdwa v3, 3, v149 dst_sel:DWORD dst_unused:UNUSED_PAD src0_sel:DWORD src1_sel:WORD_1
v_lshlrev_b32_sdwa v149, 3, v149 dst_sel:DWORD dst_unused:UNUSED_PAD src0_sel:DWORD src1_sel:WORD_0
s_waitcnt lgkmcnt(8)
v_smfmac_f32_16x16x64_bf16 v[36:39], v[4:7], v[8:15], v1
ds_read_b64 v[8:9], v148
ds_read_b64 v[10:11], v2
ds_read_b64 v[12:13], v149
ds_read_b64 v[14:15], v3
s_waitcnt vmcnt(12)
v_permlane32_swap_b32 v240, v242
v_permlane32_swap_b32 v241, v243
v_permlane32_swap_b32 v244, v246
v_permlane32_swap_b32 v245, v247
v_permlane32_swap_b32 v248, v250
v_permlane32_swap_b32 v249, v251
v_permlane32_swap_b32 v252, v254
v_permlane32_swap_b32 v253, v255
v_lshlrev_b32_sdwa v2, 3, v150 dst_sel:DWORD dst_unused:UNUSED_PAD src0_sel:DWORD src1_sel:WORD_1
v_lshlrev_b32_sdwa v150, 3, v150 dst_sel:DWORD dst_unused:UNUSED_PAD src0_sel:DWORD src1_sel:WORD_0
v_lshlrev_b32_sdwa v3, 3, v151 dst_sel:DWORD dst_unused:UNUSED_PAD src0_sel:DWORD src1_sel:WORD_1
v_lshlrev_b32_sdwa v151, 3, v151 dst_sel:DWORD dst_unused:UNUSED_PAD src0_sel:DWORD src1_sel:WORD_0
s_waitcnt lgkmcnt(8)
v_smfmac_f32_16x16x64_bf16 v[40:43], v[4:7], v[16:23], v1
ds_read_b64 v[16:17], v150
ds_read_b64 v[18:19], v2
ds_read_b64 v[20:21], v151
ds_read_b64 v[22:23], v3
v_lshlrev_b32_sdwa v2, 3, v240 dst_sel:DWORD dst_unused:UNUSED_PAD src0_sel:DWORD src1_sel:WORD_1
v_lshlrev_b32_sdwa v240, 3, v240 dst_sel:DWORD dst_unused:UNUSED_PAD src0_sel:DWORD src1_sel:WORD_0
v_lshlrev_b32_sdwa v3, 3, v241 dst_sel:DWORD dst_unused:UNUSED_PAD src0_sel:DWORD src1_sel:WORD_1
v_lshlrev_b32_sdwa v241, 3, v241 dst_sel:DWORD dst_unused:UNUSED_PAD src0_sel:DWORD src1_sel:WORD_0
s_waitcnt lgkmcnt(8)
v_smfmac_f32_16x16x64_bf16 v[40:43], v[4:7], v[24:31], v1
ds_read_b64 v[24:25], v240
ds_read_b64 v[26:27], v2
ds_read_b64 v[28:29], v241
ds_read_b64 v[30:31], v3
v_lshlrev_b32_sdwa v2, 3, v242 dst_sel:DWORD dst_unused:UNUSED_PAD src0_sel:DWORD src1_sel:WORD_1
v_lshlrev_b32_sdwa v242, 3, v242 dst_sel:DWORD dst_unused:UNUSED_PAD src0_sel:DWORD src1_sel:WORD_0
v_lshlrev_b32_sdwa v3, 3, v243 dst_sel:DWORD dst_unused:UNUSED_PAD src0_sel:DWORD src1_sel:WORD_1
v_lshlrev_b32_sdwa v243, 3, v243 dst_sel:DWORD dst_unused:UNUSED_PAD src0_sel:DWORD src1_sel:WORD_0
s_waitcnt lgkmcnt(8)
v_smfmac_f32_16x16x64_bf16 v[40:43], v[4:7], v[8:15], v1
ds_read_b64 v[8:9], v242
ds_read_b64 v[10:11], v2
ds_read_b64 v[12:13], v243
ds_read_b64 v[14:15], v3
v_lshlrev_b32_sdwa v2, 3, v244 dst_sel:DWORD dst_unused:UNUSED_PAD src0_sel:DWORD src1_sel:WORD_1
v_lshlrev_b32_sdwa v244, 3, v244 dst_sel:DWORD dst_unused:UNUSED_PAD src0_sel:DWORD src1_sel:WORD_0
v_lshlrev_b32_sdwa v3, 3, v245 dst_sel:DWORD dst_unused:UNUSED_PAD src0_sel:DWORD src1_sel:WORD_1
v_lshlrev_b32_sdwa v245, 3, v245 dst_sel:DWORD dst_unused:UNUSED_PAD src0_sel:DWORD src1_sel:WORD_0
s_waitcnt lgkmcnt(8)
v_smfmac_f32_16x16x64_bf16 v[40:43], v[4:7], v[16:23], v1
ds_read_b64 v[16:17], v244
ds_read_b64 v[18:19], v2
ds_read_b64 v[20:21], v245
ds_read_b64 v[22:23], v3
v_lshlrev_b32_sdwa v2, 3, v246 dst_sel:DWORD dst_unused:UNUSED_PAD src0_sel:DWORD src1_sel:WORD_1
v_lshlrev_b32_sdwa v246, 3, v246 dst_sel:DWORD dst_unused:UNUSED_PAD src0_sel:DWORD src1_sel:WORD_0
v_lshlrev_b32_sdwa v3, 3, v247 dst_sel:DWORD dst_unused:UNUSED_PAD src0_sel:DWORD src1_sel:WORD_1
v_lshlrev_b32_sdwa v247, 3, v247 dst_sel:DWORD dst_unused:UNUSED_PAD src0_sel:DWORD src1_sel:WORD_0
buffer_load_dwordx4 v[96:99], v0, s[4:7], s24 offen offset:0 sc1
s_waitcnt lgkmcnt(8)
v_smfmac_f32_16x16x64_bf16 v[32:35], v[4:7], v[24:31], v1
ds_read_b64 v[24:25], v246
ds_read_b64 v[26:27], v2
ds_read_b64 v[28:29], v247
ds_read_b64 v[30:31], v3
v_lshlrev_b32_sdwa v2, 3, v248 dst_sel:DWORD dst_unused:UNUSED_PAD src0_sel:DWORD src1_sel:WORD_1
v_lshlrev_b32_sdwa v248, 3, v248 dst_sel:DWORD dst_unused:UNUSED_PAD src0_sel:DWORD src1_sel:WORD_0
v_lshlrev_b32_sdwa v3, 3, v249 dst_sel:DWORD dst_unused:UNUSED_PAD src0_sel:DWORD src1_sel:WORD_1
v_lshlrev_b32_sdwa v249, 3, v249 dst_sel:DWORD dst_unused:UNUSED_PAD src0_sel:DWORD src1_sel:WORD_0
s_waitcnt lgkmcnt(8)
v_smfmac_f32_16x16x64_bf16 v[36:39], v[4:7], v[8:15], v1
ds_read_b64 v[8:9], v248
ds_read_b64 v[10:11], v2
ds_read_b64 v[12:13], v249
ds_read_b64 v[14:15], v3
v_lshlrev_b32_sdwa v2, 3, v250 dst_sel:DWORD dst_unused:UNUSED_PAD src0_sel:DWORD src1_sel:WORD_1
v_lshlrev_b32_sdwa v250, 3, v250 dst_sel:DWORD dst_unused:UNUSED_PAD src0_sel:DWORD src1_sel:WORD_0
v_lshlrev_b32_sdwa v3, 3, v251 dst_sel:DWORD dst_unused:UNUSED_PAD src0_sel:DWORD src1_sel:WORD_1
v_lshlrev_b32_sdwa v251, 3, v251 dst_sel:DWORD dst_unused:UNUSED_PAD src0_sel:DWORD src1_sel:WORD_0
s_waitcnt lgkmcnt(8)
v_smfmac_f32_16x16x64_bf16 v[40:43], v[4:7], v[16:23], v1
ds_read_b64 v[16:17], v250
ds_read_b64 v[18:19], v2
ds_read_b64 v[20:21], v251
ds_read_b64 v[22:23], v3
v_lshlrev_b32_sdwa v2, 3, v252 dst_sel:DWORD dst_unused:UNUSED_PAD src0_sel:DWORD src1_sel:WORD_1
v_lshlrev_b32_sdwa v252, 3, v252 dst_sel:DWORD dst_unused:UNUSED_PAD src0_sel:DWORD src1_sel:WORD_0
v_lshlrev_b32_sdwa v3, 3, v253 dst_sel:DWORD dst_unused:UNUSED_PAD src0_sel:DWORD src1_sel:WORD_1
v_lshlrev_b32_sdwa v253, 3, v253 dst_sel:DWORD dst_unused:UNUSED_PAD src0_sel:DWORD src1_sel:WORD_0
buffer_load_dwordx4 v[104:107], v0, s[4:7], s24 offen offset:128 sc1
s_waitcnt lgkmcnt(8)
v_smfmac_f32_16x16x64_bf16 v[44:47], v[4:7], v[24:31], v1
ds_read_b64 v[24:25], v252
ds_read_b64 v[26:27], v2
ds_read_b64 v[28:29], v253
ds_read_b64 v[30:31], v3
v_lshlrev_b32_sdwa v2, 3, v254 dst_sel:DWORD dst_unused:UNUSED_PAD src0_sel:DWORD src1_sel:WORD_1
v_lshlrev_b32_sdwa v254, 3, v254 dst_sel:DWORD dst_unused:UNUSED_PAD src0_sel:DWORD src1_sel:WORD_0
v_lshlrev_b32_sdwa v3, 3, v255 dst_sel:DWORD dst_unused:UNUSED_PAD src0_sel:DWORD src1_sel:WORD_1
v_lshlrev_b32_sdwa v255, 3, v255 dst_sel:DWORD dst_unused:UNUSED_PAD src0_sel:DWORD src1_sel:WORD_0
s_waitcnt lgkmcnt(8)
v_smfmac_f32_16x16x64_bf16 v[48:51], v[4:7], v[8:15], v1
ds_read_b64 v[8:9], v254
ds_read_b64 v[10:11], v2
ds_read_b64 v[12:13], v255
ds_read_b64 v[14:15], v3
s_waitcnt vmcnt(12)
v_lshlrev_b32_sdwa v2, 3, v152 dst_sel:DWORD dst_unused:UNUSED_PAD src0_sel:DWORD src1_sel:WORD_1
v_lshlrev_b32_sdwa v152, 3, v152 dst_sel:DWORD dst_unused:UNUSED_PAD src0_sel:DWORD src1_sel:WORD_0
v_lshlrev_b32_sdwa v3, 3, v153 dst_sel:DWORD dst_unused:UNUSED_PAD src0_sel:DWORD src1_sel:WORD_1
v_lshlrev_b32_sdwa v153, 3, v153 dst_sel:DWORD dst_unused:UNUSED_PAD src0_sel:DWORD src1_sel:WORD_0
s_waitcnt lgkmcnt(8)
v_smfmac_f32_16x16x64_bf16 v[52:55], v[4:7], v[16:23], v1
s_barrier
ds_read_b64 v[16:17], v152
ds_read_b64 v[18:19], v2
ds_read_b64 v[20:21], v153
ds_read_b64 v[22:23], v3
v_lshlrev_b32_sdwa v2, 3, v154 dst_sel:DWORD dst_unused:UNUSED_PAD src0_sel:DWORD src1_sel:WORD_1
v_lshlrev_b32_sdwa v154, 3, v154 dst_sel:DWORD dst_unused:UNUSED_PAD src0_sel:DWORD src1_sel:WORD_0
v_lshlrev_b32_sdwa v3, 3, v155 dst_sel:DWORD dst_unused:UNUSED_PAD src0_sel:DWORD src1_sel:WORD_1
v_lshlrev_b32_sdwa v155, 3, v155 dst_sel:DWORD dst_unused:UNUSED_PAD src0_sel:DWORD src1_sel:WORD_0
s_waitcnt lgkmcnt(8)
v_smfmac_f32_16x16x64_bf16 v[56:59], v[4:7], v[24:31], v1
ds_read_b64 v[24:25], v154
ds_read_b64 v[26:27], v2
ds_read_b64 v[28:29], v155
ds_read_b64 v[30:31], v3
v_lshlrev_b32_sdwa v2, 3, v156 dst_sel:DWORD dst_unused:UNUSED_PAD src0_sel:DWORD src1_sel:WORD_1
v_lshlrev_b32_sdwa v156, 3, v156 dst_sel:DWORD dst_unused:UNUSED_PAD src0_sel:DWORD src1_sel:WORD_0
v_lshlrev_b32_sdwa v3, 3, v157 dst_sel:DWORD dst_unused:UNUSED_PAD src0_sel:DWORD src1_sel:WORD_1
v_lshlrev_b32_sdwa v157, 3, v157 dst_sel:DWORD dst_unused:UNUSED_PAD src0_sel:DWORD src1_sel:WORD_0
s_waitcnt vmcnt(1)
s_mov_b32 s25, 0
rc0:
v_cmp_ne_u32_sdwa vcc, v99, s29 src0_sel:WORD_1 src1_sel:WORD_1
s_cbranch_vccnz rs0
rd0:
buffer_load_dwordx4 v[110:113], v0, s[4:7], s24 offen offset:256 sc1
s_waitcnt lgkmcnt(8)
v_smfmac_f32_16x16x64_bf16 v[60:63], v[4:7], v[8:15], v1
ds_read_b64 v[8:9], v156
ds_read_b64 v[10:11], v2
ds_read_b64 v[12:13], v157
ds_read_b64 v[14:15], v3
v_lshlrev_b32_sdwa v2, 3, v158 dst_sel:DWORD dst_unused:UNUSED_PAD src0_sel:DWORD src1_sel:WORD_1
v_lshlrev_b32_sdwa v158, 3, v158 dst_sel:DWORD dst_unused:UNUSED_PAD src0_sel:DWORD src1_sel:WORD_0
v_lshlrev_b32_sdwa v3, 3, v159 dst_sel:DWORD dst_unused:UNUSED_PAD src0_sel:DWORD src1_sel:WORD_1
v_lshlrev_b32_sdwa v159, 3, v159 dst_sel:DWORD dst_unused:UNUSED_PAD src0_sel:DWORD src1_sel:WORD_0
v_lshlrev_b32 v95, 16, v96
v_add_f32 v32, v32, v95
v_and_b32 v95, 0xffff0000, v96
v_add_f32 v33, v33, v95
v_lshlrev_b32 v95, 16, v97
v_add_f32 v34, v34, v95
v_and_b32 v95, 0xffff0000, v97
v_add_f32 v35, v35, v95
v_max_f32 v32, s0, v32
v_max_f32 v33, s1, v33
v_max_f32 v34, s52, v34
v_max_f32 v35, s53, v35
v_fma_f32 v72, v32, s56, v67
v_fma_f32 v72, v33, s57, v72
v_fma_f32 v72, v34, s58, v72
v_fma_f32 v72, v35, s59, v72
v_and_or_b32 v72, v72, s22, v70
s_waitcnt lgkmcnt(8)
v_smfmac_f32_16x16x64_bf16 v[44:47], v[4:7], v[16:23], v1
ds_read_b64 v[16:17], v158
ds_read_b64 v[18:19], v2
ds_read_b64 v[20:21], v159
ds_read_b64 v[22:23], v3
s_waitcnt vmcnt(11)
v_lshlrev_b32_sdwa v2, 3, v160 dst_sel:DWORD dst_unused:UNUSED_PAD src0_sel:DWORD src1_sel:WORD_1
v_lshlrev_b32_sdwa v160, 3, v160 dst_sel:DWORD dst_unused:UNUSED_PAD src0_sel:DWORD src1_sel:WORD_0
v_lshlrev_b32_sdwa v3, 3, v161 dst_sel:DWORD dst_unused:UNUSED_PAD src0_sel:DWORD src1_sel:WORD_1
v_lshlrev_b32_sdwa v161, 3, v161 dst_sel:DWORD dst_unused:UNUSED_PAD src0_sel:DWORD src1_sel:WORD_0
s_waitcnt lgkmcnt(8)
v_smfmac_f32_16x16x64_bf16 v[44:47], v[4:7], v[24:31], v1
ds_read_b64 v[24:25], v160
ds_read_b64 v[26:27], v2
ds_read_b64 v[28:29], v161
ds_read_b64 v[30:31], v3
v_lshlrev_b32_sdwa v2, 3, v162 dst_sel:DWORD dst_unused:UNUSED_PAD src0_sel:DWORD src1_sel:WORD_1
v_lshlrev_b32_sdwa v162, 3, v162 dst_sel:DWORD dst_unused:UNUSED_PAD src0_sel:DWORD src1_sel:WORD_0
v_lshlrev_b32_sdwa v3, 3, v163 dst_sel:DWORD dst_unused:UNUSED_PAD src0_sel:DWORD src1_sel:WORD_1
v_lshlrev_b32_sdwa v163, 3, v163 dst_sel:DWORD dst_unused:UNUSED_PAD src0_sel:DWORD src1_sel:WORD_0
s_waitcnt lgkmcnt(8)
v_smfmac_f32_16x16x64_bf16 v[44:47], v[4:7], v[8:15], v1
ds_read_b64 v[8:9], v162
ds_read_b64 v[10:11], v2
ds_read_b64 v[12:13], v163
ds_read_b64 v[14:15], v3
v_lshlrev_b32_sdwa v2, 3, v164 dst_sel:DWORD dst_unused:UNUSED_PAD src0_sel:DWORD src1_sel:WORD_1
v_lshlrev_b32_sdwa v164, 3, v164 dst_sel:DWORD dst_unused:UNUSED_PAD src0_sel:DWORD src1_sel:WORD_0
v_lshlrev_b32_sdwa v3, 3, v165 dst_sel:DWORD dst_unused:UNUSED_PAD src0_sel:DWORD src1_sel:WORD_1
v_lshlrev_b32_sdwa v165, 3, v165 dst_sel:DWORD dst_unused:UNUSED_PAD src0_sel:DWORD src1_sel:WORD_0
s_waitcnt vmcnt(1)
s_mov_b32 s25, 0
rc1:
v_cmp_ne_u32_sdwa vcc, v107, s29 src0_sel:WORD_1 src1_sel:WORD_1
s_cbranch_vccnz rs1
rd1:
buffer_load_dwordx4 v[118:121], v0, s[4:7], s24 offen offset:384 sc1
s_waitcnt lgkmcnt(8)
v_smfmac_f32_16x16x64_bf16 v[44:47], v[4:7], v[16:23], v1
ds_read_b64 v[16:17], v164
ds_read_b64 v[18:19], v2
ds_read_b64 v[20:21], v165
ds_read_b64 v[22:23], v3
v_lshlrev_b32_sdwa v2, 3, v166 dst_sel:DWORD dst_unused:UNUSED_PAD src0_sel:DWORD src1_sel:WORD_1
v_lshlrev_b32_sdwa v166, 3, v166 dst_sel:DWORD dst_unused:UNUSED_PAD src0_sel:DWORD src1_sel:WORD_0
v_lshlrev_b32_sdwa v3, 3, v167 dst_sel:DWORD dst_unused:UNUSED_PAD src0_sel:DWORD src1_sel:WORD_1
v_lshlrev_b32_sdwa v167, 3, v167 dst_sel:DWORD dst_unused:UNUSED_PAD src0_sel:DWORD src1_sel:WORD_0
v_lshlrev_b32 v95, 16, v98
v_add_f32 v36, v36, v95
v_and_b32 v95, 0xffff0000, v98
v_add_f32 v37, v37, v95
v_lshlrev_b32 v95, 16, v99
v_add_f32 v38, v38, v95
v_lshlrev_b32 v95, 16, v104
v_add_f32 v39, v39, v95
v_max_f32 v36, s0, v36
v_max_f32 v37, s1, v37
v_max_f32 v38, s52, v38
v_max_f32 v39, s53, v39
v_fma_f32 v73, v36, s56, v67
v_fma_f32 v73, v37, s57, v73
v_fma_f32 v73, v38, s58, v73
v_fma_f32 v73, v39, s59, v73
v_and_or_b32 v73, v73, s22, v70
s_waitcnt lgkmcnt(8)
v_smfmac_f32_16x16x64_bf16 v[48:51], v[4:7], v[24:31], v1
ds_read_b64 v[24:25], v166
ds_read_b64 v[26:27], v2
ds_read_b64 v[28:29], v167
ds_read_b64 v[30:31], v3
s_waitcnt vmcnt(9)
v_lshlrev_b32_sdwa v2, 3, v168 dst_sel:DWORD dst_unused:UNUSED_PAD src0_sel:DWORD src1_sel:WORD_1
v_lshlrev_b32_sdwa v168, 3, v168 dst_sel:DWORD dst_unused:UNUSED_PAD src0_sel:DWORD src1_sel:WORD_0
v_lshlrev_b32_sdwa v3, 3, v169 dst_sel:DWORD dst_unused:UNUSED_PAD src0_sel:DWORD src1_sel:WORD_1
v_lshlrev_b32_sdwa v169, 3, v169 dst_sel:DWORD dst_unused:UNUSED_PAD src0_sel:DWORD src1_sel:WORD_0
v_and_b32 v95, 0xffff0000, v104
v_add_f32 v40, v40, v95
v_lshlrev_b32 v95, 16, v105
v_add_f32 v41, v41, v95
v_and_b32 v95, 0xffff0000, v105
v_add_f32 v42, v42, v95
v_lshlrev_b32 v95, 16, v106
v_add_f32 v43, v43, v95
v_max_f32 v40, s0, v40
v_max_f32 v41, s1, v41
v_max_f32 v42, s52, v42
v_max_f32 v43, s53, v43
v_fma_f32 v74, v40, s56, v67
v_fma_f32 v74, v41, s57, v74
v_fma_f32 v74, v42, s58, v74
v_fma_f32 v74, v43, s59, v74
v_and_or_b32 v74, v74, s22, v70
s_waitcnt lgkmcnt(8)
v_smfmac_f32_16x16x64_bf16 v[48:51], v[4:7], v[8:15], v1
ds_read_b64 v[8:9], v168
ds_read_b64 v[10:11], v2
ds_read_b64 v[12:13], v169
ds_read_b64 v[14:15], v3
v_lshlrev_b32_sdwa v2, 3, v170 dst_sel:DWORD dst_unused:UNUSED_PAD src0_sel:DWORD src1_sel:WORD_1
v_lshlrev_b32_sdwa v170, 3, v170 dst_sel:DWORD dst_unused:UNUSED_PAD src0_sel:DWORD src1_sel:WORD_0
v_lshlrev_b32_sdwa v3, 3, v171 dst_sel:DWORD dst_unused:UNUSED_PAD src0_sel:DWORD src1_sel:WORD_1
v_lshlrev_b32_sdwa v171, 3, v171 dst_sel:DWORD dst_unused:UNUSED_PAD src0_sel:DWORD src1_sel:WORD_0
s_waitcnt lgkmcnt(8)
v_smfmac_f32_16x16x64_bf16 v[48:51], v[4:7], v[16:23], v1
ds_read_b64 v[16:17], v170
ds_read_b64 v[18:19], v2
ds_read_b64 v[20:21], v171
ds_read_b64 v[22:23], v3
v_lshlrev_b32_sdwa v2, 3, v172 dst_sel:DWORD dst_unused:UNUSED_PAD src0_sel:DWORD src1_sel:WORD_1
v_lshlrev_b32_sdwa v172, 3, v172 dst_sel:DWORD dst_unused:UNUSED_PAD src0_sel:DWORD src1_sel:WORD_0
v_lshlrev_b32_sdwa v3, 3, v173 dst_sel:DWORD dst_unused:UNUSED_PAD src0_sel:DWORD src1_sel:WORD_1
v_lshlrev_b32_sdwa v173, 3, v173 dst_sel:DWORD dst_unused:UNUSED_PAD src0_sel:DWORD src1_sel:WORD_0
s_waitcnt vmcnt(1)
s_mov_b32 s25, 0
rc2:
v_cmp_ne_u32_sdwa vcc, v113, s29 src0_sel:WORD_1 src1_sel:WORD_1
s_cbranch_vccnz rs2
rd2:
buffer_load_dwordx4 v[124:127], v0, s[4:7], s24 offen offset:512 sc1
s_waitcnt lgkmcnt(8)
v_smfmac_f32_16x16x64_bf16 v[48:51], v[4:7], v[24:31], v1
ds_read_b64 v[24:25], v172
ds_read_b64 v[26:27], v2
ds_read_b64 v[28:29], v173
ds_read_b64 v[30:31], v3
v_lshlrev_b32_sdwa v2, 3, v174 dst_sel:DWORD dst_unused:UNUSED_PAD src0_sel:DWORD src1_sel:WORD_1
v_lshlrev_b32_sdwa v174, 3, v174 dst_sel:DWORD dst_unused:UNUSED_PAD src0_sel:DWORD src1_sel:WORD_0
v_lshlrev_b32_sdwa v3, 3, v175 dst_sel:DWORD dst_unused:UNUSED_PAD src0_sel:DWORD src1_sel:WORD_1
v_lshlrev_b32_sdwa v175, 3, v175 dst_sel:DWORD dst_unused:UNUSED_PAD src0_sel:DWORD src1_sel:WORD_0
v_and_b32 v95, 0xffff0000, v106
v_add_f32 v44, v44, v95
v_lshlrev_b32 v95, 16, v107
v_add_f32 v45, v45, v95
v_lshlrev_b32 v95, 16, v110
v_add_f32 v46, v46, v95
v_and_b32 v95, 0xffff0000, v110
v_add_f32 v47, v47, v95
v_max_f32 v44, s0, v44
v_max_f32 v45, s1, v45
v_max_f32 v46, s52, v46
v_max_f32 v47, s53, v47
v_fma_f32 v75, v44, s56, v67
v_fma_f32 v75, v45, s57, v75
v_fma_f32 v75, v46, s58, v75
v_fma_f32 v75, v47, s59, v75
v_and_or_b32 v75, v75, s22, v70
buffer_store_dwordx4 v[72:75], v68, s[4:7], s70 offen sc1
s_waitcnt lgkmcnt(8)
v_smfmac_f32_16x16x64_bf16 v[52:55], v[4:7], v[8:15], v1
ds_read_b64 v[8:9], v174
ds_read_b64 v[10:11], v2
ds_read_b64 v[12:13], v175
ds_read_b64 v[14:15], v3
s_waitcnt vmcnt(8)
v_lshlrev_b32_sdwa v2, 3, v176 dst_sel:DWORD dst_unused:UNUSED_PAD src0_sel:DWORD src1_sel:WORD_1
v_lshlrev_b32_sdwa v176, 3, v176 dst_sel:DWORD dst_unused:UNUSED_PAD src0_sel:DWORD src1_sel:WORD_0
v_lshlrev_b32_sdwa v3, 3, v177 dst_sel:DWORD dst_unused:UNUSED_PAD src0_sel:DWORD src1_sel:WORD_1
v_lshlrev_b32_sdwa v177, 3, v177 dst_sel:DWORD dst_unused:UNUSED_PAD src0_sel:DWORD src1_sel:WORD_0
s_waitcnt lgkmcnt(8)
v_smfmac_f32_16x16x64_bf16 v[52:55], v[4:7], v[16:23], v1
ds_read_b64 v[16:17], v176
ds_read_b64 v[18:19], v2
ds_read_b64 v[20:21], v177
ds_read_b64 v[22:23], v3
v_lshlrev_b32_sdwa v2, 3, v178 dst_sel:DWORD dst_unused:UNUSED_PAD src0_sel:DWORD src1_sel:WORD_1
v_lshlrev_b32_sdwa v178, 3, v178 dst_sel:DWORD dst_unused:UNUSED_PAD src0_sel:DWORD src1_sel:WORD_0
v_lshlrev_b32_sdwa v3, 3, v179 dst_sel:DWORD dst_unused:UNUSED_PAD src0_sel:DWORD src1_sel:WORD_1
v_lshlrev_b32_sdwa v179, 3, v179 dst_sel:DWORD dst_unused:UNUSED_PAD src0_sel:DWORD src1_sel:WORD_0
v_lshlrev_b32 v95, 16, v111
v_add_f32 v48, v48, v95
v_and_b32 v95, 0xffff0000, v111
v_add_f32 v49, v49, v95
v_lshlrev_b32 v95, 16, v112
v_add_f32 v50, v50, v95
v_and_b32 v95, 0xffff0000, v112
v_add_f32 v51, v51, v95
v_max_f32 v48, s0, v48
v_max_f32 v49, s1, v49
v_max_f32 v50, s52, v50
v_max_f32 v51, s53, v51
v_fma_f32 v76, v48, s56, v67
v_fma_f32 v76, v49, s57, v76
v_fma_f32 v76, v50, s58, v76
v_fma_f32 v76, v51, s59, v76
v_and_or_b32 v76, v76, s22, v70
s_waitcnt lgkmcnt(8)
v_smfmac_f32_16x16x64_bf16 v[52:55], v[4:7], v[24:31], v1
ds_read_b64 v[24:25], v178
ds_read_b64 v[26:27], v2
ds_read_b64 v[28:29], v179
ds_read_b64 v[30:31], v3
v_lshlrev_b32_sdwa v2, 3, v180 dst_sel:DWORD dst_unused:UNUSED_PAD src0_sel:DWORD src1_sel:WORD_1
v_lshlrev_b32_sdwa v180, 3, v180 dst_sel:DWORD dst_unused:UNUSED_PAD src0_sel:DWORD src1_sel:WORD_0
v_lshlrev_b32_sdwa v3, 3, v181 dst_sel:DWORD dst_unused:UNUSED_PAD src0_sel:DWORD src1_sel:WORD_1
v_lshlrev_b32_sdwa v181, 3, v181 dst_sel:DWORD dst_unused:UNUSED_PAD src0_sel:DWORD src1_sel:WORD_0
s_waitcnt vmcnt(2)
s_mov_b32 s25, 0
rc3:
v_cmp_ne_u32_sdwa vcc, v121, s29 src0_sel:WORD_1 src1_sel:WORD_1
s_cbranch_vccnz rs3
rd3:
s_waitcnt lgkmcnt(8)
v_smfmac_f32_16x16x64_bf16 v[52:55], v[4:7], v[8:15], v1
ds_read_b64 v[8:9], v180
ds_read_b64 v[10:11], v2
ds_read_b64 v[12:13], v181
ds_read_b64 v[14:15], v3
v_lshlrev_b32_sdwa v2, 3, v182 dst_sel:DWORD dst_unused:UNUSED_PAD src0_sel:DWORD src1_sel:WORD_1
v_lshlrev_b32_sdwa v182, 3, v182 dst_sel:DWORD dst_unused:UNUSED_PAD src0_sel:DWORD src1_sel:WORD_0
v_lshlrev_b32_sdwa v3, 3, v183 dst_sel:DWORD dst_unused:UNUSED_PAD src0_sel:DWORD src1_sel:WORD_1
v_lshlrev_b32_sdwa v183, 3, v183 dst_sel:DWORD dst_unused:UNUSED_PAD src0_sel:DWORD src1_sel:WORD_0
s_waitcnt lgkmcnt(8)
v_smfmac_f32_16x16x64_bf16 v[56:59], v[4:7], v[16:23], v1
ds_read_b64 v[16:17], v182
ds_read_b64 v[18:19], v2
ds_read_b64 v[20:21], v183
ds_read_b64 v[22:23], v3
s_waitcnt vmcnt(6)
v_lshlrev_b32_sdwa v2, 3, v184 dst_sel:DWORD dst_unused:UNUSED_PAD src0_sel:DWORD src1_sel:WORD_1
v_lshlrev_b32_sdwa v184, 3, v184 dst_sel:DWORD dst_unused:UNUSED_PAD src0_sel:DWORD src1_sel:WORD_0
v_lshlrev_b32_sdwa v3, 3, v185 dst_sel:DWORD dst_unused:UNUSED_PAD src0_sel:DWORD src1_sel:WORD_1
v_lshlrev_b32_sdwa v185, 3, v185 dst_sel:DWORD dst_unused:UNUSED_PAD src0_sel:DWORD src1_sel:WORD_0
s_waitcnt lgkmcnt(8)
v_smfmac_f32_16x16x64_bf16 v[56:59], v[4:7], v[24:31], v1
ds_read_b64 v[24:25], v184
ds_read_b64 v[26:27], v2
ds_read_b64 v[28:29], v185
ds_read_b64 v[30:31], v3
v_lshlrev_b32_sdwa v2, 3, v186 dst_sel:DWORD dst_unused:UNUSED_PAD src0_sel:DWORD src1_sel:WORD_1
v_lshlrev_b32_sdwa v186, 3, v186 dst_sel:DWORD dst_unused:UNUSED_PAD src0_sel:DWORD src1_sel:WORD_0
v_lshlrev_b32_sdwa v3, 3, v187 dst_sel:DWORD dst_unused:UNUSED_PAD src0_sel:DWORD src1_sel:WORD_1
v_lshlrev_b32_sdwa v187, 3, v187 dst_sel:DWORD dst_unused:UNUSED_PAD src0_sel:DWORD src1_sel:WORD_0
v_lshlrev_b32 v95, 16, v113
v_add_f32 v52, v52, v95
v_lshlrev_b32 v95, 16, v118
v_add_f32 v53, v53, v95
v_and_b32 v95, 0xffff0000, v118
v_add_f32 v54, v54, v95
v_lshlrev_b32 v95, 16, v119
v_add_f32 v55, v55, v95
v_max_f32 v52, s0, v52
v_max_f32 v53, s1, v53
v_max_f32 v54, s52, v54
v_max_f32 v55, s53, v55
v_fma_f32 v77, v52, s56, v67
v_fma_f32 v77, v53, s57, v77
v_fma_f32 v77, v54, s58, v77
v_fma_f32 v77, v55, s59, v77
v_and_or_b32 v77, v77, s22, v70
s_waitcnt lgkmcnt(8)
v_smfmac_f32_16x16x64_bf16 v[56:59], v[4:7], v[8:15], v1
ds_read_b64 v[8:9], v186
ds_read_b64 v[10:11], v2
ds_read_b64 v[12:13], v187
ds_read_b64 v[14:15], v3
v_lshlrev_b32_sdwa v2, 3, v188 dst_sel:DWORD dst_unused:UNUSED_PAD src0_sel:DWORD src1_sel:WORD_1
v_lshlrev_b32_sdwa v188, 3, v188 dst_sel:DWORD dst_unused:UNUSED_PAD src0_sel:DWORD src1_sel:WORD_0
v_lshlrev_b32_sdwa v3, 3, v189 dst_sel:DWORD dst_unused:UNUSED_PAD src0_sel:DWORD src1_sel:WORD_1
v_lshlrev_b32_sdwa v189, 3, v189 dst_sel:DWORD dst_unused:UNUSED_PAD src0_sel:DWORD src1_sel:WORD_0
s_waitcnt vmcnt(1)
s_mov_b32 s25, 0
rc4:
v_xor_b32 v124, v70, v124
v_xor_b32 v125, v70, v125
v_xor_b32 v126, v70, v126
v_xor_b32 v127, v70, v127
v_or3_b32 v95, v124, v125, v126
v_or_b32 v95, v95, v127
v_and_b32 v95, 255, v95
v_cmp_ne_u32 vcc, 0, v95
s_cbranch_vccnz rs4
rd4:
s_waitcnt lgkmcnt(8)
v_smfmac_f32_16x16x64_bf16 v[56:59], v[4:7], v[16:23], v1
ds_read_b64 v[16:17], v188
ds_read_b64 v[18:19], v2
ds_read_b64 v[20:21], v189
ds_read_b64 v[22:23], v3
v_lshlrev_b32_sdwa v2, 3, v190 dst_sel:DWORD dst_unused:UNUSED_PAD src0_sel:DWORD src1_sel:WORD_1
v_lshlrev_b32_sdwa v190, 3, v190 dst_sel:DWORD dst_unused:UNUSED_PAD src0_sel:DWORD src1_sel:WORD_0
v_lshlrev_b32_sdwa v3, 3, v191 dst_sel:DWORD dst_unused:UNUSED_PAD src0_sel:DWORD src1_sel:WORD_1
v_lshlrev_b32_sdwa v191, 3, v191 dst_sel:DWORD dst_unused:UNUSED_PAD src0_sel:DWORD src1_sel:WORD_0
s_waitcnt lgkmcnt(8)
v_smfmac_f32_16x16x64_bf16 v[60:63], v[4:7], v[24:31], v1
ds_read_b64 v[24:25], v190
ds_read_b64 v[26:27], v2
ds_read_b64 v[28:29], v191
ds_read_b64 v[30:31], v3
s_waitcnt lgkmcnt(8)
v_smfmac_f32_16x16x64_bf16 v[60:63], v[4:7], v[8:15], v1
s_waitcnt lgkmcnt(4)
v_smfmac_f32_16x16x64_bf16 v[60:63], v[4:7], v[16:23], v1
v_and_b32 v95, 0xffff0000, v119
v_add_f32 v56, v56, v95
v_lshlrev_b32 v95, 16, v120
v_add_f32 v57, v57, v95
v_and_b32 v95, 0xffff0000, v120
v_add_f32 v58, v58, v95
v_lshlrev_b32 v95, 16, v121
v_add_f32 v59, v59, v95
v_max_f32 v56, s0, v56
v_max_f32 v57, s1, v57
v_max_f32 v58, s52, v58
v_max_f32 v59, s53, v59
v_fma_f32 v78, v56, s56, v67
v_fma_f32 v78, v57, s57, v78
v_fma_f32 v78, v58, s58, v78
v_fma_f32 v78, v59, s59, v78
v_and_or_b32 v78, v78, s22, v70
s_waitcnt lgkmcnt(0)
v_smfmac_f32_16x16x64_bf16 v[60:63], v[4:7], v[24:31], v1
v_lshlrev_b32 v69, 4, v64
s_lshl_b32 s70, s28, 14
s_lshl_b32 s30, s3, 11
s_add_u32 s70, s70, s30
s_add_u32 s70, s70, 0x600000
s_lshl_b32 s30, s3, 8
s_add_u32 s30, s30, 128000
v_lshl_add_u32 v71, v64, 2, s30
s_nop 0
v_add_f32 v60, v60, v124
v_add_f32 v61, v61, v125
v_add_f32 v62, v62, v126
v_add_f32 v63, v63, v127
v_max_f32 v60, s0, v60
v_max_f32 v61, s1, v61
v_max_f32 v62, s52, v62
v_max_f32 v63, s53, v63
v_fma_f32 v79, v60, s56, v67
v_fma_f32 v79, v61, s57, v79
v_fma_f32 v79, v62, s58, v79
v_fma_f32 v79, v63, s59, v79
v_and_or_b32 v79, v79, s22, v70
buffer_store_dwordx4 v[76:79], v68, s[4:7], s71 offen sc1
s_cmp_lg_u32 s3, 0
s_cbranch_scc1 nowide2
s_waitcnt vmcnt(2)
s_lshl_b32 s68, s68, 16
s_lshl_b32 s69, s69, 16
v_mov_b32 v93, s68
v_add_f32 v93, s69, v93
s_lshl_b32 s30, s60, 16
v_lshlrev_b32 v80, 16, v80
v_fma_f32 v93, v80, s30, v93
s_and_b32 s30, s60, 0xffff0000
v_lshlrev_b32 v81, 16, v81
v_fma_f32 v93, v81, s30, v93
s_lshl_b32 s30, s61, 16
v_lshlrev_b32 v82, 16, v82
v_fma_f32 v93, v82, s30, v93
s_and_b32 s30, s61, 0xffff0000
v_lshlrev_b32 v83, 16, v83
v_fma_f32 v93, v83, s30, v93
s_lshl_b32 s30, s62, 16
v_lshlrev_b32 v84, 16, v84
v_fma_f32 v93, v84, s30, v93
s_and_b32 s30, s62, 0xffff0000
v_lshlrev_b32 v85, 16, v85
v_fma_f32 v93, v85, s30, v93
s_lshl_b32 s30, s63, 16
v_lshlrev_b32 v86, 16, v86
v_fma_f32 v93, v86, s30, v93
s_and_b32 s30, s63, 0xffff0000
v_lshlrev_b32 v87, 16, v87
v_fma_f32 v93, v87, s30, v93
s_lshl_b32 s30, s64, 16
v_lshlrev_b32 v88, 16, v88
v_fma_f32 v93, v88, s30, v93
s_and_b32 s30, s64, 0xffff0000
v_lshlrev_b32 v89, 16, v89
v_fma_f32 v93, v89, s30, v93
s_lshl_b32 s30, s65, 16
v_lshlrev_b32 v90, 16, v90
v_fma_f32 v93, v90, s30, v93
s_and_b32 s30, s65, 0xffff0000
v_lshlrev_b32 v91, 16, v91
v_fma_f32 v93, v91, s30, v93
s_lshl_b32 s30, s66, 16
v_lshlrev_b32 v92, 16, v92
v_fma_f32 v93, v92, s30, v93
nowide2:
s_mov_b32 s25, 0
s_waitcnt vmcnt(0)
s_barrier
poll2:
buffer_load_dwordx4 v[208:211], v69, s[4:7], s70 offen sc1
buffer_load_dwordx4 v[212:215], v69, s[4:7], s70 offen offset:1024 sc1
s_add_u32 s25, s25, 1
s_cmp_gt_u32 s25, 0x40000
s_cbranch_scc1 poll2_done
s_waitcnt vmcnt(0)
v_xor_b32 v208, v70, v208
v_xor_b32 v209, v70, v209
v_xor_b32 v210, v70, v210
v_xor_b32 v211, v70, v211
v_xor_b32 v212, v70, v212
v_xor_b32 v213, v70, v213
v_xor_b32 v214, v70, v214
v_xor_b32 v215, v70, v215
v_or3_b32 v216, v208, v209, v210
v_or3_b32 v217, v211, v212, v213
v_or3_b32 v216, v216, v214, v215
v_or_b32 v216, v216, v217
v_and_b32 v216, 255, v216
v_cmp_ne_u32 vcc, 0, v216
s_cbranch_vccnz poll2
poll2_done:
s_waitcnt vmcnt(0)
v_add_f32 v208, v208, v212
v_add_f32 v209, v209, v213
v_add_f32 v210, v210, v214
v_add_f32 v211, v211, v215
s_nop 1
v_permlane32_swap_b32 v208, v210
v_permlane32_swap_b32 v209, v211
v_add_f32 v208, v208, v210
v_add_f32 v209, v209, v211
s_nop 1
v_permlane16_swap_b32 v208, v209
v_add_f32 v208, v208, v209
ds_write_b32 v71, v208
s_waitcnt lgkmcnt(0)
s_barrier
s_cmp_lg_u32 s3, 0
s_cbranch_scc1 fin
ds_read_b32 v209, v71 offset:256
ds_read_b32 v210, v71 offset:512
ds_read_b32 v211, v71 offset:768
ds_read_b32 v212, v71 offset:1024
ds_read_b32 v213, v71 offset:1280
ds_read_b32 v214, v71 offset:1536
ds_read_b32 v215, v71 offset:1792
v_add_f32 v208, v208, v93
v_lshlrev_b32 v65, 1, v65
s_waitcnt lgkmcnt(0)
v_add_f32 v209, v209, v210
v_add_f32 v211, v211, v212
v_add_f32 v213, v213, v214
v_add_f32 v208, v208, v215
v_add_f32 v209, v209, v211
v_add_f32 v208, v208, v213
v_add_f32 v208, v208, v209
v_mul_f32 v208, 0xbfb8aa3b, v208
v_exp_f32 v208, v208
s_nop 0
v_add_f32 v208, 1.0, v208
v_rcp_f32 v208, v208
s_nop 0
v_cvt_pk_bf16_f32 v208, v208, v208
buffer_store_short v208, v65, s[12:15], 0 offen
s_cmp_lg_u32 s2, 0
s_cbranch_scc1 fin
v_mov_b32 v209, s29
v_mov_b32 v210, 39552
s_mov_b64 exec, 1
buffer_store_dword v209, v210, s[4:7], 0 offen
s_mov_b64 exec, -1
fin:
s_endpgm
rs0:
s_add_u32 s25, s25, 1
s_cmp_gt_u32 s25, 0x40000
s_cbranch_scc1 rd0
s_sleep 4
buffer_load_dwordx4 v[96:99], v0, s[4:7], s24 offen offset:0 sc1
s_waitcnt vmcnt(0)
s_branch rc0
rs1:
s_add_u32 s25, s25, 1
s_cmp_gt_u32 s25, 0x40000
s_cbranch_scc1 rd1
s_sleep 4
buffer_load_dwordx4 v[104:107], v0, s[4:7], s24 offen offset:128 sc1
s_waitcnt vmcnt(0)
s_branch rc1
rs2:
s_add_u32 s25, s25, 1
s_cmp_gt_u32 s25, 0x40000
s_cbranch_scc1 rd2
s_sleep 4
buffer_load_dwordx4 v[110:113], v0, s[4:7], s24 offen offset:256 sc1
s_waitcnt vmcnt(0)
s_branch rc2
rs3:
s_add_u32 s25, s25, 1
s_cmp_gt_u32 s25, 0x40000
s_cbranch_scc1 rd3
s_sleep 4
buffer_load_dwordx4 v[118:121], v0, s[4:7], s24 offen offset:384 sc1
s_waitcnt vmcnt(0)
s_branch rc3
rs4:
s_add_u32 s25, s25, 1
s_cmp_gt_u32 s25, 0x40000
s_cbranch_scc1 rd4
s_sleep 4
buffer_load_dwordx4 v[124:127], v0, s[4:7], s24 offen offset:512 sc1
s_waitcnt vmcnt(0)
s_branch rc4
done:
s_endpgm
.section .rodata,"a"
.p2align 6
.amdhsa_kernel standalone__deep_cross_wide_deep__recsys_kernel
  .amdhsa_next_free_vgpr 256
  .amdhsa_next_free_sgpr 102
  .amdhsa_accum_offset 256
  .amdhsa_group_segment_fixed_size 0
  .amdhsa_kernarg_size 96
  .amdhsa_user_sgpr_count 2
  .amdhsa_user_sgpr_kernarg_segment_ptr 1
  .amdhsa_system_sgpr_workgroup_id_x 1
.end_amdhsa_kernel
```
